```python
import torch

def _softmax(x, axis=-1):
    return torch.softmax(x, dim=axis)
def _gelu(x):
    return torch.nn.functional.gelu(x, approximate="tanh")
def _silu(x):
    return torch.nn.functional.silu(x)
def _sigmoid(x):
    return torch.sigmoid(x)
def _layernorm(x, axis=-1, eps=1e-5):
    m = x.mean(dim=axis, keepdim=True)
    v = x.var(dim=axis, keepdim=True, unbiased=False)
    return (x - m) / torch.sqrt(v + eps)
def _scatter_add(tgt, idx, src, axis=0):
    return tgt.clone().index_add_(axis, idx, src)
def _segment_sum(src, seg, n):
    out = torch.zeros((n,) + src.shape[1:], dtype=src.dtype)
    return out.index_add_(0, seg, src)
def _pad(x, pw):
    flat = tuple(v for pair in reversed(pw) for v in pair)
    return torch.nn.functional.pad(x, flat)

kernel_name = 'gated_mix__mha_block__mixer_channel_mlp__prompt'

def setup_inputs():

    _w = (lambda a: (lambda t: t.to(torch.bfloat16) if t.is_floating_point() else t)(torch.as_tensor(a)))
    def _A_setup():
        B, S, D, H = 1, 2048, 512, 32
        return {
            "x": _w((lambda *s: torch.randn(*s, dtype=torch.bfloat16) * 0.05)(B, S, D)),
            "wqkv": _w((lambda *s: torch.randn(*s, dtype=torch.bfloat16) * 0.8)(D, 3 * D)),
            "wo": _w((lambda *s: torch.randn(*s, dtype=torch.bfloat16) * 0.1)(D, D)),
        }
    _A_in = _A_setup()

    def _B_setup():
        B, S, D, F = 1, 2048, 512, 1792
        return {
            "x": _w((lambda *s: torch.randn(*s, dtype=torch.bfloat16) * 0.05)(B, S, D)),
            "w1": _w((lambda *s: torch.randn(*s, dtype=torch.bfloat16) * 1.6)(D, F) * (D ** -0.5)),
            "b1": _w((lambda *s: torch.randn(*s, dtype=torch.bfloat16) * 0.8)(F)),
            "w2": _w((lambda *s: torch.randn(*s, dtype=torch.bfloat16) * 0.05)(F, D) * (F ** -0.5)),
            "b2": _w((lambda *s: torch.randn(*s, dtype=torch.bfloat16) * 0.05)(D)),
        }
    _B_in = _B_setup()

    return {
        "A_x": _A_in["x"],
        "A_wqkv": _A_in["wqkv"],
        "A_wo": _A_in["wo"],
        "B_x": _B_in["x"],
        "B_w1": _B_in["w1"],
        "B_b1": _B_in["b1"],
        "B_w2": _B_in["w2"],
        "B_b2": _B_in["b2"],
        "gate_w": _w((lambda *s: torch.randn(*s, dtype=torch.bfloat16) * 0.05)(512) * 16.0),
    }

def reference(A_x, A_wqkv, A_wo, B_x, B_w1, B_b1, B_w2, B_b2, gate_w):
    def _A_ref(x, wqkv, wo):
        B, S, D = x.shape
        H = 32
        Dh = D // H
        qkv = (lambda x, *d: x.permute(*d))((x @ wqkv).reshape(B, S, 3, H, Dh), 2, 0, 3, 1, 4)
        q, k, v = qkv[0], qkv[1], qkv[2]
        scores = torch.einsum("bhqd,bhkd->bhqk", q, k) * (Dh ** -0.5)
        p = _softmax(scores, axis=-1)
        o = torch.einsum("bhqk,bhkd->bhqd", p, v)
        return (lambda x, *d: x.permute(*d))(o, 0, 2, 1, 3).reshape(B, S, D) @ wo

    def _B_ref(x, w1, b1, w2, b2):
        y = _layernorm(x, axis=-1)
        h = _gelu(torch.einsum("bsd,df->bsf", y, w1) + b1)
        return torch.einsum("bsf,fd->bsd", h, w2) + b2

    x = A_x
    g = _sigmoid((x * gate_w).sum(-1, keepdims=True))
    a = _A_ref(x, A_wqkv, A_wo)
    b = _B_ref(x, B_w1, B_b1, B_w2, B_b2)
    return g * a + (1 - g) * b
```

```asm
; @launch grid=(256,1,1) block=(512,1,1) lds=163840
.amdgcn_target "amdgcn-amd-amdhsa--gfx950"
.text
.globl gated_mix__mha_block__mixer_channel_mlp__prompt_kernel
.p2align 8
.type gated_mix__mha_block__mixer_channel_mlp__prompt_kernel,@function
gated_mix__mha_block__mixer_channel_mlp__prompt_kernel:
s_cmp_ge_u32 s2, 256
s_cbranch_scc1 L_END

s_load_dwordx8 s[40:47], s[0:1], 0
s_load_dwordx8 s[48:55], s[0:1], 32
s_load_dwordx8 s[56:63], s[0:1], 64
v_lshrrev_b32 v1, 6, v0
v_and_b32 v0, 63, v0
s_and_b32 s65, s2, 7
v_readfirstlane_b32 s3, v1
s_lshr_b32 s66, s2, 3
s_and_b32 s67, s65, 1
s_lshl_b32 s67, s67, 3
s_and_b32 s83, s66, 7
s_add_u32 s5, s67, s83
s_lshr_b32 s67, s65, 1
s_lshl_b32 s67, s67, 2
s_lshr_b32 s68, s66, 3
s_add_u32 s6, s67, s68
s_lshl_b32 s67, s68, 1
s_add_u32 s7, s5, s67
s_and_b32 s96, s7, 7
s_and_b32 s7, s7, 6

s_lshl_b32 s65, s65, 2
s_add_u32 s82, s65, s68
s_mov_b32 s84, s82
s_mov_b32 s85, s83
s_and_b32 s4, s3, 3
s_cmp_ge_u32 s3, 4
s_cbranch_scc0 L_G
v_lshrrev_b32 v1, 3, v0
v_lshrrev_b32 v2, 4, v0
v_xor_b32 v2, v2, v0
v_and_b32 v2, 7, v2
v_lshlrev_b32 v2, 4, v2
v_lshl_add_u32 v112, v1, 10, v2
v_xor_b32 v3, 64, v112
v_add_u32 v113, 7168, v3
v_add_u32 v114, 14336, v112
v_add_u32 v115, 21504, v3
v_lshrrev_b32 v1, 2, v0
v_and_b32 v2, 3, v0
v_lshlrev_b32 v2, 4, v2
v_mul_u32_u24 v3, 3072, v1
v_add_u32 v116, v3, v2
v_lshrrev_b32 v1, 3, v0
v_mul_u32_u24 v3, 3584, v1
v_bfe_u32 v1, v0, 4, 1
v_lshlrev_b32 v1, 2, v1
v_xor_b32 v1, v1, v0
v_and_b32 v1, 7, v1
v_lshl_add_u32 v117, v1, 4, v3
v_add_u32 v119, 27648, v117
s_lshl_b32 s74, s5, 17
s_lshl_b32 s65, s4, 15
s_add_u32 s74, s74, s65
s_mul_i32 s75, s4, 49152
s_mul_i32 s65, s6, 192
s_add_u32 s75, s75, s65
s_lshl_b32 s76, s4, 12
s_mul_i32 s77, s4, 3072
s_add_u32 s77, s77, 16384
s_waitcnt lgkmcnt(0)
s_mov_b32 s8, s40
s_and_b32 s9, s41, 0xffff
s_mov_b32 s10, 0x200000
s_mov_b32 s11, 0x20000
s_mov_b32 s12, s42
s_and_b32 s13, s43, 0xffff
s_mov_b32 s14, 0x180000
s_mov_b32 s15, 0x20000
s_add_u32 s65, s7, 0
s_and_b32 s65, s65, 7
s_lshl_b32 s66, s65, 7
s_add_u32 s66, s66, s74
s_add_u32 m0, s76, 0
s_mul_i32 s67, s65, 196608
buffer_load_dwordx4 v112, s[8:11], s66 offen offset:0  lds
buffer_load_dwordx4 v113, s[8:11], s66 offen offset:1024  lds
buffer_load_dwordx4 v114, s[8:11], s66 offen offset:2048  lds
buffer_load_dwordx4 v115, s[8:11], s66 offen offset:3072  lds
s_add_u32 m0, s77, 0
s_add_u32 s67, s67, s75
buffer_load_dwordx4 v116, s[12:15], s67 offen  lds
s_add_u32 m0, m0, 960
s_nop 0
buffer_load_dwordx4 v116, s[12:15], s67 offen offset:64  lds
s_add_u32 m0, m0, 960
s_nop 0
buffer_load_dwordx4 v116, s[12:15], s67 offen offset:128  lds
s_add_u32 s65, s7, 1
s_and_b32 s65, s65, 7
s_lshl_b32 s66, s65, 7
s_add_u32 s66, s66, s74
s_add_u32 m0, s76, 28672
s_mul_i32 s67, s65, 196608
buffer_load_dwordx4 v112, s[8:11], s66 offen offset:0  lds
buffer_load_dwordx4 v113, s[8:11], s66 offen offset:1024  lds
buffer_load_dwordx4 v114, s[8:11], s66 offen offset:2048  lds
buffer_load_dwordx4 v115, s[8:11], s66 offen offset:3072  lds
s_add_u32 m0, s77, 28672
s_add_u32 s67, s67, s75
buffer_load_dwordx4 v116, s[12:15], s67 offen  lds
s_add_u32 m0, m0, 960
s_nop 0
buffer_load_dwordx4 v116, s[12:15], s67 offen offset:64  lds
s_add_u32 m0, m0, 960
s_nop 0
buffer_load_dwordx4 v116, s[12:15], s67 offen offset:128  lds
s_mov_b32 s16, s48
s_and_b32 s17, s49, 0xffff
s_mov_b32 s18, 0x1c0000
s_mov_b32 s19, 0x20000
s_mov_b32 s28, s62
s_and_b32 s29, s63, 0xffff
s_mov_b32 s30, 0x1800000
s_mov_b32 s31, 0x20000
v_and_b32 v1, 31, v0
v_lshrrev_b32 v2, 5, v0
v_bfe_u32 v3, v0, 1, 3
v_xor_b32 v2, v2, v3
v_lshlrev_b32 v2, 4, v2
v_lshl_add_u32 v2, v1, 7, v2
s_lshl_b32 s65, s4, 12
v_add_u32 v4, s65, v2
v_xor_b32 v5, 32, v4
v_xor_b32 v6, 64, v4
v_xor_b32 v7, 0x60, v4
v_and_b32 v1, 15, v0
v_lshrrev_b32 v2, 4, v0
v_xor_b32 v3, v1, v2
v_and_b32 v3, 1, v3
v_lshrrev_b32 v16, 2, v1
v_or_b32 v3, v3, v16
v_lshrrev_b32 v16, 1, v2
v_cmp_gt_u32 vcc, 2, v1
v_mov_b32 v17, 2
s_nop 0
v_cndmask_b32 v16, v16, v17, vcc
v_cmp_eq_u32 vcc, 0, v3
v_mov_b32 v17, 3
s_nop 0
v_cndmask_b32 v16, v17, v16, vcc
v_lshlrev_b32 v16, 4, v16
v_add_u32 v126, 155648, v16
v_lshrrev_b32 v1, 5, v0
v_lshlrev_b32 v1, 10, v1
v_bfe_u32 v2, v0, 2, 2
v_lshl_add_u32 v1, v2, 7, v1
v_bfe_u32 v2, v0, 4, 1
v_lshl_add_u32 v1, v2, 5, v1
v_and_b32 v2, 1, v0
v_lshl_add_u32 v1, v2, 4, v1
v_bfe_u32 v2, v0, 1, 1
v_lshl_add_u32 v1, v2, 3, v1
v_bfe_u32 v2, v0, 3, 1
v_lshlrev_b32 v2, 6, v2
v_xor_b32 v102, v1, v2
v_lshrrev_b32 v2, 5, v0
v_lshlrev_b32 v2, 5, v2
v_add_u32 v100, 157696, v2
v_mov_b32 v101, 0xc0135761
v_lshlrev_b32 v14, 4, v0
s_lshr_b32 s65, s6, 2
s_mul_i32 s65, s65, 14
s_and_b32 s66, s6, 3
s_lshl_b32 s67, s66, 3
s_lshr_b32 s68, 0x0a080400, s67
s_and_b32 s68, s68, 0xff
s_add_u32 s78, s65, s68
s_lshr_b32 s68, 0x0c060602, s67
s_and_b32 s68, s68, 0xff
s_add_u32 s79, s65, s68
s_cmp_lg_u32 s66, 2
s_cselect_b32 s80, 1, 0
s_cmp_lg_u32 s66, 1
s_cselect_b32 s81, 1, 0
s_lshr_b32 s65, s82, 1
s_mul_i32 s66, s65, 0x5556
s_lshr_b32 s69, s66, 16
s_add_u32 s66, s65, 16
s_mul_i32 s66, s66, 0x5556
s_lshr_b32 s66, s66, 16
s_add_u32 s67, s65, 32
s_mul_i32 s67, s67, 0x5556
s_lshr_b32 s67, s67, 16
s_lshl_b32 s68, s83, 5
s_add_u32 s68, s68, s69
v_and_b32 v16, 15, v0
v_lshlrev_b32 v16, 4, v16
v_add_u32 v17, s66, v16
v_add_u32 v18, s67, v16
v_and_b32 v19, 1, v0
v_lshlrev_b32 v19, 4, v19
v_add_u32 v19, s68, v19
v_cmp_gt_u32 vcc, 16, v0
s_nop 1
v_cndmask_b32 v17, v18, v17, vcc
v_cmp_gt_u32 vcc, 32, v0
s_nop 1
v_cndmask_b32 v17, v19, v17, vcc
v_lshlrev_b32 v17, 6, v17
v_add_u32 v123, 19922944, v17
v_add_u32 v94, 86016, v14
v_lshrrev_b32 v16, 5, v0
v_lshlrev_b32 v16, 8, v16
v_and_b32 v17, 15, v0
v_lshl_add_u32 v16, v17, 4, v16
v_add_u32 v16, 118784, v16
v_add_u32 v18, -4, v17
v_cmp_gt_u32 vcc, 8, v18
v_mov_b32 v18, 151552
v_mov_b32 v19, 151616
v_cndmask_b32 v18, v18, v19, vcc
v_and_b32 v17, 11, v17
v_cmp_ne_u32 vcc, 0, v17
v_add_u32 v19, 16, v18
v_mov_b32 v96, 0xdddddddd
v_cndmask_b32 v17, v18, v19, vcc
v_bfe_u32 v18, v0, 4, 1
v_xor_b32 v99, 1, v18
v_cmp_eq_u32 vcc, 0, v18
s_nop 1
v_cndmask_b32 v95, v17, v16, vcc
s_waitcnt vmcnt(7)
s_barrier
ds_read_b128 v[128:131], v4 offset:0
ds_read_b128 v[132:135], v5 offset:0
ds_read_b128 v[136:139], v6 offset:0
ds_read_b128 v[140:143], v7 offset:0
s_add_u32 s65, s7, 2
s_and_b32 s65, s65, 7
s_lshl_b32 s66, s65, 7
s_add_u32 s66, s66, s74
s_add_u32 m0, s76, 57344
s_mul_i32 s67, s65, 196608
buffer_load_dwordx4 v112, s[8:11], s66 offen offset:0  lds
buffer_load_dwordx4 v113, s[8:11], s66 offen offset:1024  lds
buffer_load_dwordx4 v114, s[8:11], s66 offen offset:2048  lds
buffer_load_dwordx4 v115, s[8:11], s66 offen offset:3072  lds
s_add_u32 m0, s77, 57344
s_add_u32 s67, s67, s75
buffer_load_dwordx4 v116, s[12:15], s67 offen  lds
s_add_u32 m0, m0, 960
s_nop 0
buffer_load_dwordx4 v116, s[12:15], s67 offen offset:64  lds
s_add_u32 m0, m0, 960
s_nop 0
buffer_load_dwordx4 v116, s[12:15], s67 offen offset:128  lds
s_cmp_eq_u32 s4, 1
s_cbranch_scc1 L_A_T1
s_cmp_eq_u32 s4, 2
s_cbranch_scc1 L_A_T2
s_cmp_eq_u32 s4, 3
s_cbranch_scc1 L_A_T3
s_mov_b32 s36, s56
s_and_b32 s37, s57, 0xffff
s_mov_b32 s38, 0x400
s_mov_b32 s39, 0x20000
buffer_load_dwordx4 v[16:19], v14, s[36:39], 0 offen
s_branch L_A_TD
L_A_T1:
s_mov_b32 s36, s50
s_and_b32 s37, s51, 0xffff
s_mov_b32 s38, 0xe00
s_mov_b32 s39, 0x20000
v_and_b32 v1, 31, v0
v_lshlrev_b32 v1, 2, v1
s_lshl_b32 s65, s78, 6
s_lshl_b32 s66, s79, 6
v_add_u32 v2, s65, v1
v_add_u32 v3, s66, v1
v_cmp_gt_u32 vcc, 32, v0
s_nop 1
v_cndmask_b32 v2, v3, v2, vcc
buffer_load_dword v16, v2, s[36:39], 0 offen
s_branch L_A_TD
L_A_T2:
s_mov_b32 s36, s54
s_and_b32 s37, s55, 0xffff
s_mov_b32 s38, 0x400
s_mov_b32 s39, 0x20000
v_and_b32 v1, 31, v0
v_lshlrev_b32 v2, 2, v1
s_lshl_b32 s65, s85, 7
buffer_load_dword v16, v2, s[36:39], s65 offen
s_branch L_A_TD
L_A_T3:
s_lshl_b32 s65, s96, 6
v_add_u32 v1, s65, v0
v_mul_u32_u24 v1, 3584, v1
s_lshl_b32 s65, s79, 6
s_or_b32 s65, s65, 2130706432
buffer_load_dword v16, v1, s[16:19], s65 offen
L_A_TD:
s_waitcnt vmcnt(8) lgkmcnt(0)
s_barrier
ds_read_b128 v[144:147], v4 offset:28672
ds_read_b128 v[148:151], v5 offset:28672
ds_read_b128 v[152:155], v6 offset:28672
ds_read_b128 v[156:159], v7 offset:28672
s_add_u32 s65, s7, 3
s_and_b32 s65, s65, 7
s_lshl_b32 s66, s65, 7
s_add_u32 s66, s66, s74
s_add_u32 m0, s76, 86016
s_mul_i32 s67, s65, 196608
buffer_load_dwordx4 v112, s[8:11], s66 offen offset:0  lds
buffer_load_dwordx4 v113, s[8:11], s66 offen offset:1024  lds
buffer_load_dwordx4 v114, s[8:11], s66 offen offset:2048  lds
buffer_load_dwordx4 v115, s[8:11], s66 offen offset:3072  lds
s_add_u32 m0, s77, 86016
s_add_u32 s67, s67, s75
buffer_load_dwordx4 v116, s[12:15], s67 offen  lds
s_add_u32 m0, m0, 960
s_nop 0
buffer_load_dwordx4 v116, s[12:15], s67 offen offset:64  lds
s_add_u32 m0, m0, 960
s_nop 0
buffer_load_dwordx4 v116, s[12:15], s67 offen offset:128  lds
s_waitcnt vmcnt(8) lgkmcnt(0)
s_barrier
ds_read_b128 v[160:163], v4 offset:57344
ds_read_b128 v[164:167], v5 offset:57344
ds_read_b128 v[168:171], v6 offset:57344
ds_read_b128 v[172:175], v7 offset:57344
s_add_u32 s65, s7, 4
s_and_b32 s65, s65, 7
s_lshl_b32 s66, s65, 7
s_add_u32 s66, s66, s74
s_add_u32 m0, s76, 114688
s_mul_i32 s67, s65, 196608
buffer_load_dwordx4 v112, s[8:11], s66 offen offset:0  lds
buffer_load_dwordx4 v113, s[8:11], s66 offen offset:1024  lds
buffer_load_dwordx4 v114, s[8:11], s66 offen offset:2048  lds
buffer_load_dwordx4 v115, s[8:11], s66 offen offset:3072  lds
s_add_u32 m0, s77, 114688
s_add_u32 s67, s67, s75
buffer_load_dwordx4 v116, s[12:15], s67 offen  lds
s_add_u32 m0, m0, 960
s_nop 0
buffer_load_dwordx4 v116, s[12:15], s67 offen offset:64  lds
s_add_u32 m0, m0, 960
s_nop 0
buffer_load_dwordx4 v116, s[12:15], s67 offen offset:128  lds
s_waitcnt vmcnt(7) lgkmcnt(0)
s_barrier
v_add_u32 v4, 0x10000, v4
v_add_u32 v5, 0x10000, v5
v_add_u32 v6, 0x10000, v6
v_add_u32 v7, 0x10000, v7
ds_read_b128 v[176:179], v4 offset:20480
ds_read_b128 v[180:183], v5 offset:20480
ds_read_b128 v[184:187], v6 offset:20480
ds_read_b128 v[188:191], v7 offset:20480
s_add_u32 s65, s7, 5
s_and_b32 s65, s65, 7
s_lshl_b32 s66, s65, 7
s_add_u32 s66, s66, s74
s_add_u32 m0, s76, 0
s_mul_i32 s67, s65, 196608
buffer_load_dwordx4 v112, s[8:11], s66 offen offset:0  lds
buffer_load_dwordx4 v113, s[8:11], s66 offen offset:1024  lds
buffer_load_dwordx4 v114, s[8:11], s66 offen offset:2048  lds
buffer_load_dwordx4 v115, s[8:11], s66 offen offset:3072  lds
s_add_u32 m0, s77, 0
s_add_u32 s67, s67, s75
buffer_load_dwordx4 v116, s[12:15], s67 offen  lds
s_add_u32 m0, m0, 960
s_nop 0
buffer_load_dwordx4 v116, s[12:15], s67 offen offset:64  lds
s_add_u32 m0, m0, 960
s_nop 0
buffer_load_dwordx4 v116, s[12:15], s67 offen offset:128  lds
s_waitcnt vmcnt(7) lgkmcnt(0)
s_barrier
ds_read_b128 v[192:195], v4 offset:49152
ds_read_b128 v[196:199], v5 offset:49152
ds_read_b128 v[200:203], v6 offset:49152
ds_read_b128 v[204:207], v7 offset:49152
s_add_u32 s65, s7, 6
s_and_b32 s65, s65, 7
s_lshl_b32 s66, s65, 7
s_add_u32 s66, s66, s74
s_add_u32 m0, s76, 28672
s_mul_i32 s67, s65, 196608
buffer_load_dwordx4 v112, s[8:11], s66 offen offset:0  lds
buffer_load_dwordx4 v113, s[8:11], s66 offen offset:1024  lds
buffer_load_dwordx4 v114, s[8:11], s66 offen offset:2048  lds
buffer_load_dwordx4 v115, s[8:11], s66 offen offset:3072  lds
s_add_u32 m0, s77, 28672
s_add_u32 s67, s67, s75
buffer_load_dwordx4 v116, s[12:15], s67 offen  lds
s_add_u32 m0, m0, 960
s_nop 0
buffer_load_dwordx4 v116, s[12:15], s67 offen offset:64  lds
s_add_u32 m0, m0, 960
s_nop 0
buffer_load_dwordx4 v116, s[12:15], s67 offen offset:128  lds
s_waitcnt vmcnt(7) lgkmcnt(0)
s_barrier
v_add_u32 v4, 0xffff0000, v4
v_add_u32 v5, 0xffff0000, v5
v_add_u32 v6, 0xffff0000, v6
v_add_u32 v7, 0xffff0000, v7
ds_read_b128 v[208:211], v4 offset:0
ds_read_b128 v[212:215], v5 offset:0
ds_read_b128 v[216:219], v6 offset:0
ds_read_b128 v[220:223], v7 offset:0
s_add_u32 s65, s7, 7
s_and_b32 s65, s65, 7
s_lshl_b32 s66, s65, 7
s_add_u32 s66, s66, s74
s_add_u32 m0, s76, 57344
s_mul_i32 s67, s65, 196608
buffer_load_dwordx4 v112, s[8:11], s66 offen offset:0  lds
buffer_load_dwordx4 v113, s[8:11], s66 offen offset:1024  lds
buffer_load_dwordx4 v114, s[8:11], s66 offen offset:2048  lds
buffer_load_dwordx4 v115, s[8:11], s66 offen offset:3072  lds
s_add_u32 m0, s77, 57344
s_add_u32 s67, s67, s75
buffer_load_dwordx4 v116, s[12:15], s67 offen  lds
s_add_u32 m0, m0, 960
s_nop 0
buffer_load_dwordx4 v116, s[12:15], s67 offen offset:64  lds
s_add_u32 m0, m0, 960
s_nop 0
buffer_load_dwordx4 v116, s[12:15], s67 offen offset:128  lds
s_waitcnt vmcnt(7) lgkmcnt(0)
s_barrier
ds_read_b128 v[224:227], v4 offset:28672
ds_read_b128 v[228:231], v5 offset:28672
ds_read_b128 v[232:235], v6 offset:28672
ds_read_b128 v[236:239], v7 offset:28672
s_cmp_eq_u32 s4, 1
s_cbranch_scc1 L_A_W1
s_cmp_eq_u32 s4, 2
s_cbranch_scc1 L_A_W2
s_cmp_eq_u32 s4, 3
s_cbranch_scc1 L_A_W3
v_lshrrev_b32 v1, 1, v0
s_lshl_b32 s65, s7, 2
v_subrev_u32 v1, s65, v1
v_and_b32 v1, 31, v1
v_lshlrev_b32 v1, 6, v1
v_and_b32 v2, 1, v0
v_lshl_add_u32 v1, v2, 4, v1
v_add_u32 v1, 155648, v1
v_and_b32 v2, 31, v0
v_lshlrev_b32 v2, 6, v2
v_lshrrev_b32 v3, 5, v0
v_lshl_add_u32 v2, v3, 4, v2
v_add_u32 v2, 155680, v2
v_subrev_u32 v3, 1, v3
v_and_b32 v20, 0x3f803f80, v3
v_mov_b32 v21, v20
v_mov_b32 v22, v20
v_mov_b32 v23, v20
ds_write_b128 v2, v[20:23]
ds_write_b128 v1, v[16:19]
s_branch L_A_WD
L_A_W1:
v_lshlrev_b32 v1, 3, v0
v_add_u32 v1, 158208, v1
v_and_b32 v17, 0xffff0000, v16
v_lshlrev_b32 v16, 16, v16
ds_write_b64 v1, v[16:17]
s_branch L_A_WD
L_A_W2:
v_and_b32 v1, 31, v0
v_lshlrev_b32 v1, 3, v1
v_add_u32 v1, 163584, v1
v_and_b32 v17, 0xffff0000, v16
v_lshlrev_b32 v16, 16, v16
ds_write_b64 v1, v[16:17]
s_branch L_A_WD
L_A_W3:
v_add_u32 v1, 151552, v14
v_and_b32 v17, 11, v0
v_cmp_eq_u32 vcc, 0, v17
v_mov_b32 v16, 0
v_mov_b32 v17, 0x3f803f80
v_cndmask_b32 v16, v16, v17, vcc
v_mov_b32 v17, v16
v_mov_b32 v18, v16
v_mov_b32 v19, v16
ds_write_b128 v1, v[16:19] offset:0
ds_write_b128 v1, v[16:19] offset:1024
ds_write_b128 v1, v[16:19] offset:2048
ds_write_b128 v1, v[16:19] offset:3072
L_A_WD:
s_sub_u32 s99, s96, s7
s_and_b32 s99, s99, 7
s_mov_b32 s100, s96
s_lshl_b32 s97, s4, 11
s_add_u32 s97, s97, 86016
s_mul_i32 s98, s4, 57344
s_lshl_b32 s65, s78, 6
s_add_u32 s98, s98, s65
s_lshl_b32 s65, s99, 13
s_add_u32 m0, s65, s97
s_mul_i32 s66, s100, 229376
s_add_u32 s66, s66, s98
buffer_load_dwordx4 v117, s[16:19], s66 offen lds
buffer_load_dwordx4 v119, s[16:19], s66 offen offset:1024 lds
s_add_u32 s99, s99, 1
s_and_b32 s99, s99, 7
s_add_u32 s100, s100, 1
s_and_b32 s100, s100, 7
s_lshl_b32 s65, s99, 13
s_add_u32 m0, s65, s97
s_mul_i32 s66, s100, 229376
s_add_u32 s66, s66, s98
buffer_load_dwordx4 v117, s[16:19], s66 offen lds
buffer_load_dwordx4 v119, s[16:19], s66 offen offset:1024 lds
s_add_u32 s99, s99, 1
s_and_b32 s99, s99, 7
s_add_u32 s100, s100, 1
s_and_b32 s100, s100, 7
s_lshl_b32 s65, s99, 13
s_add_u32 m0, s65, s97
s_mul_i32 s66, s100, 229376
s_add_u32 s66, s66, s98
buffer_load_dwordx4 v117, s[16:19], s66 offen lds
buffer_load_dwordx4 v119, s[16:19], s66 offen offset:1024 lds
s_add_u32 s99, s99, 1
s_and_b32 s99, s99, 7
s_add_u32 s100, s100, 1
s_and_b32 s100, s100, 7
s_lshl_b32 s65, s99, 13
s_add_u32 m0, s65, s97
s_mul_i32 s66, s100, 229376
s_add_u32 s66, s66, s98
buffer_load_dwordx4 v117, s[16:19], s66 offen lds
buffer_load_dwordx4 v119, s[16:19], s66 offen offset:1024 lds
s_add_u32 s99, s99, 1
s_and_b32 s99, s99, 7
s_add_u32 s100, s100, 1
s_and_b32 s100, s100, 7
s_waitcnt vmcnt(8) lgkmcnt(0)
s_barrier
ds_read_b128 v[240:243], v4 offset:57344
ds_read_b128 v[244:247], v5 offset:57344
ds_read_b128 v[248:251], v6 offset:57344
ds_read_b128 v[252:255], v7 offset:57344
s_lshl_b32 s65, s99, 13
s_add_u32 m0, s65, s97
s_mul_i32 s66, s100, 229376
s_add_u32 s66, s66, s98
buffer_load_dwordx4 v117, s[16:19], s66 offen lds
buffer_load_dwordx4 v119, s[16:19], s66 offen offset:1024 lds
s_add_u32 s99, s99, 1
s_and_b32 s99, s99, 7
s_add_u32 s100, s100, 1
s_and_b32 s100, s100, 7
s_lshl_b32 s65, s99, 13
s_add_u32 m0, s65, s97
s_mul_i32 s66, s100, 229376
s_add_u32 s66, s66, s98
buffer_load_dwordx4 v117, s[16:19], s66 offen lds
buffer_load_dwordx4 v119, s[16:19], s66 offen offset:1024 lds
s_add_u32 s99, s99, 1
s_and_b32 s99, s99, 7
s_add_u32 s100, s100, 1
s_and_b32 s100, s100, 7
s_lshl_b32 s65, s99, 13
s_add_u32 m0, s65, s97
s_mul_i32 s66, s100, 229376
s_add_u32 s66, s66, s98
buffer_load_dwordx4 v117, s[16:19], s66 offen lds
buffer_load_dwordx4 v119, s[16:19], s66 offen offset:1024 lds
s_add_u32 s99, s99, 1
s_and_b32 s99, s99, 7
s_add_u32 s100, s100, 1
s_and_b32 s100, s100, 7
s_lshl_b32 s65, s99, 13
s_add_u32 m0, s65, s97
s_mul_i32 s66, s100, 229376
s_add_u32 s66, s66, s98
buffer_load_dwordx4 v117, s[16:19], s66 offen lds
buffer_load_dwordx4 v119, s[16:19], s66 offen offset:1024 lds
s_add_u32 s99, s99, 1
s_and_b32 s99, s99, 7
s_add_u32 s100, s100, 1
s_and_b32 s100, s100, 7
v_mov_b32 v1, 161024
ds_read_b32 v3, v1
ds_read_b128 v[32:35], v126 offset:0
ds_read_b128 v[36:39], v126 offset:64
ds_read_b128 v[40:43], v126 offset:128
ds_read_b128 v[44:47], v126 offset:192
ds_read_b128 v[48:51], v126 offset:256
ds_read_b128 v[52:55], v126 offset:320
ds_read_b128 v[56:59], v126 offset:384
s_waitcnt lgkmcnt(7)
s_barrier
s_waitcnt lgkmcnt(6)
v_mfma_f32_16x16x32_bf16 v[16:19], v[32:35], v[128:131], 0
ds_read_b128 v[60:63], v126 offset:448
s_waitcnt lgkmcnt(6)
v_mfma_f32_16x16x32_bf16 v[16:19], v[36:39], v[132:135], v[16:19]
ds_read_b128 v[32:35], v126 offset:512
s_waitcnt lgkmcnt(6)
v_mfma_f32_16x16x32_bf16 v[16:19], v[40:43], v[136:139], v[16:19]
ds_read_b128 v[36:39], v126 offset:576
s_waitcnt lgkmcnt(6)
v_mfma_f32_16x16x32_bf16 v[16:19], v[44:47], v[140:143], v[16:19]
ds_read_b128 v[40:43], v126 offset:640
s_waitcnt lgkmcnt(6)
v_mfma_f32_16x16x32_bf16 v[16:19], v[48:51], v[144:147], v[16:19]
ds_read_b128 v[44:47], v126 offset:704
s_waitcnt lgkmcnt(6)
v_mfma_f32_16x16x32_bf16 v[16:19], v[52:55], v[148:151], v[16:19]
ds_read_b128 v[48:51], v126 offset:768
s_waitcnt lgkmcnt(6)
v_mfma_f32_16x16x32_bf16 v[16:19], v[56:59], v[152:155], v[16:19]
ds_read_b128 v[52:55], v126 offset:832
s_waitcnt lgkmcnt(6)
v_mfma_f32_16x16x32_bf16 v[16:19], v[60:63], v[156:159], v[16:19]
ds_read_b128 v[56:59], v126 offset:896
s_waitcnt lgkmcnt(6)
v_mfma_f32_16x16x32_bf16 v[16:19], v[32:35], v[160:163], v[16:19]
ds_read_b128 v[60:63], v126 offset:960
s_waitcnt lgkmcnt(6)
v_mfma_f32_16x16x32_bf16 v[16:19], v[36:39], v[164:167], v[16:19]
ds_read_b128 v[32:35], v126 offset:1024
s_waitcnt lgkmcnt(6)
v_mfma_f32_16x16x32_bf16 v[16:19], v[40:43], v[168:171], v[16:19]
ds_read_b128 v[36:39], v126 offset:1088
s_waitcnt lgkmcnt(6)
v_mfma_f32_16x16x32_bf16 v[16:19], v[44:47], v[172:175], v[16:19]
ds_read_b128 v[40:43], v126 offset:1152
s_waitcnt lgkmcnt(6)
v_mfma_f32_16x16x32_bf16 v[16:19], v[48:51], v[176:179], v[16:19]
ds_read_b128 v[44:47], v126 offset:1216
s_waitcnt lgkmcnt(6)
v_mfma_f32_16x16x32_bf16 v[16:19], v[52:55], v[180:183], v[16:19]
ds_read_b128 v[48:51], v126 offset:1280
s_waitcnt lgkmcnt(6)
v_mfma_f32_16x16x32_bf16 v[16:19], v[56:59], v[184:187], v[16:19]
ds_read_b128 v[52:55], v126 offset:1344
s_waitcnt lgkmcnt(6)
v_mfma_f32_16x16x32_bf16 v[16:19], v[60:63], v[188:191], v[16:19]
ds_read_b128 v[56:59], v126 offset:1408
s_waitcnt lgkmcnt(6)
v_mfma_f32_16x16x32_bf16 v[16:19], v[32:35], v[192:195], v[16:19]
ds_read_b128 v[60:63], v126 offset:1472
s_waitcnt lgkmcnt(6)
v_mfma_f32_16x16x32_bf16 v[16:19], v[36:39], v[196:199], v[16:19]
ds_read_b128 v[32:35], v126 offset:1536
s_waitcnt lgkmcnt(6)
v_mfma_f32_16x16x32_bf16 v[16:19], v[40:43], v[200:203], v[16:19]
ds_read_b128 v[36:39], v126 offset:1600
s_waitcnt lgkmcnt(6)
v_mfma_f32_16x16x32_bf16 v[16:19], v[44:47], v[204:207], v[16:19]
ds_read_b128 v[40:43], v126 offset:1664
s_waitcnt lgkmcnt(6)
v_mfma_f32_16x16x32_bf16 v[16:19], v[48:51], v[208:211], v[16:19]
ds_read_b128 v[44:47], v126 offset:1728
s_waitcnt lgkmcnt(6)
v_mfma_f32_16x16x32_bf16 v[16:19], v[52:55], v[212:215], v[16:19]
ds_read_b128 v[48:51], v126 offset:1792
s_waitcnt lgkmcnt(6)
v_mfma_f32_16x16x32_bf16 v[16:19], v[56:59], v[216:219], v[16:19]
ds_read_b128 v[52:55], v126 offset:1856
s_waitcnt lgkmcnt(6)
v_mfma_f32_16x16x32_bf16 v[16:19], v[60:63], v[220:223], v[16:19]
ds_read_b128 v[56:59], v126 offset:1920
s_waitcnt lgkmcnt(6)
v_mfma_f32_16x16x32_bf16 v[16:19], v[32:35], v[224:227], v[16:19]
ds_read_b128 v[60:63], v126 offset:1984
s_waitcnt lgkmcnt(6)
v_mfma_f32_16x16x32_bf16 v[16:19], v[36:39], v[228:231], v[16:19]
s_waitcnt lgkmcnt(5)
v_mfma_f32_16x16x32_bf16 v[16:19], v[40:43], v[232:235], v[16:19]
s_waitcnt lgkmcnt(4)
v_mfma_f32_16x16x32_bf16 v[16:19], v[44:47], v[236:239], v[16:19]
s_waitcnt lgkmcnt(3)
v_mfma_f32_16x16x32_bf16 v[16:19], v[48:51], v[240:243], v[16:19]
s_waitcnt lgkmcnt(2)
v_mfma_f32_16x16x32_bf16 v[16:19], v[52:55], v[244:247], v[16:19]
s_waitcnt lgkmcnt(1)
v_mfma_f32_16x16x32_bf16 v[16:19], v[56:59], v[248:251], v[16:19]
s_waitcnt lgkmcnt(0)
v_mfma_f32_16x16x32_bf16 v[16:19], v[60:63], v[252:255], v[16:19]
v_readfirstlane_b32 s64, v3
v_and_b32 v1, 31, v0
v_lshlrev_b32 v2, 4, v1
s_lshl_b32 s65, s4, 9
s_add_u32 s65, s65, 158976
v_add_u32 v122, s65, v2
s_nop 2
v_permlane16_swap_b32 v16, v17
v_permlane16_swap_b32 v18, v19
v_mov_b32 v17, v16
v_mov_b32 v19, v18
s_nop 0
v_permlane32_swap_b32 v16, v17
v_permlane32_swap_b32 v18, v19
v_mul_f32 v18, 0xbfb8aa3b, v18
v_mul_f32 v16, 0x3b000000, v16
v_exp_f32 v18, v18
s_nop 0
v_max_f32 v17, 0x0d800000, v18
v_add_f32 v18, 1.0, v18
v_rcp_f32 v17, v17
v_rcp_f32 v18, v18
s_nop 0
v_add_f32 v17, 1.0, v17
ds_write_b64 v122, v[16:17]
ds_write_b32 v122, v18 offset:8
s_waitcnt vmcnt(0) lgkmcnt(0)
s_barrier
s_sub_u32 s99, s96, s7
s_and_b32 s99, s99, 7
s_mov_b32 s100, s96
s_lshl_b32 s97, s4, 11
s_add_u32 s97, s97, 0
s_mul_i32 s98, s4, 57344
s_lshl_b32 s65, s79, 6
s_add_u32 s98, s98, s65
s_lshl_b32 s65, s99, 13
s_add_u32 m0, s65, s97
s_mul_i32 s66, s100, 229376
s_add_u32 s66, s66, s98
buffer_load_dwordx4 v117, s[16:19], s66 offen lds
buffer_load_dwordx4 v119, s[16:19], s66 offen offset:1024 lds
s_add_u32 s99, s99, 1
s_and_b32 s99, s99, 7
s_add_u32 s100, s100, 1
s_and_b32 s100, s100, 7
v_xor_b32 v11, 64, v102
v_add_u32 v11, 86016, v11
s_setprio 1
s_call_b64 s[72:73], L_TILE
s_setprio 0
s_barrier
ds_read_b64 v[12:13], v122 offset:8
ds_read_b32 v118, v122 offset:4
s_mov_b32 s47, 128
s_call_b64 s[72:73], L_EPI
s_waitcnt vmcnt(0)
buffer_load_dwordx4 v[76:79], v123, s[28:31], 0 offen sc1
s_barrier
s_mov_b32 s46, 100000
L_PA:
s_waitcnt vmcnt(0)
v_xor_b32 v76, s64, v76
v_xor_b32 v77, s64, v77
v_xor_b32 v78, s64, v78
v_xor_b32 v79, s64, v79
v_or3_b32 v76, v76, v77, v78
v_or_b32 v76, v76, v79
v_cmp_ne_u32 vcc, 0, v76
s_cbranch_vccz L_PA_ok
s_sub_u32 s46, s46, 1
s_cbranch_scc1 L_PA_ok
buffer_load_dwordx4 v[76:79], v123, s[28:31], 0 offen sc1
s_branch L_PA
L_PA_ok:
s_lshr_b32 s65, s82, 1
s_mul_i32 s66, s65, 0x5556
s_lshr_b32 s75, s66, 16
s_lshl_b32 s65, s82, 16
s_lshl_b32 s66, s83, 13
s_add_u32 s65, s65, s66
s_lshl_b32 s66, s4, 11
s_add_u32 s65, s65, s66
buffer_load_dwordx4 v[120:123], v14, s[28:31], s65 offen sc1
buffer_load_dwordx4 v[124:127], v14, s[28:31], s65 offen offset:1024 sc1
s_lshl_b32 s65, s75, 13
s_lshl_b32 s66, s83, 10
s_add_u32 s65, s65, s66
s_lshl_b32 s66, s4, 8
s_add_u32 s65, s65, s66
s_add_u32 s65, s65, 18874368
v_and_b32 v76, 31, v0
v_lshlrev_b32 v76, 2, v76
buffer_load_dword v1, v76, s[28:31], s65 offen sc1
buffer_load_dword v2, v76, s[28:31], s65 offen offset:128 sc1
s_cmp_eq_u32 s81, 0
s_cbranch_scc1 L_A_NOD2
s_lshl_b32 s65, s4, 11
s_add_u32 s97, s65, 86016
s_lshl_b32 s98, s82, 16
s_add_u32 s98, s98, s65
s_lshl_b32 s99, s83, 3
v_xor_b32 v11, 64, v102
s_setprio 1
s_call_b64 s[72:73], L_TILEK
s_setprio 0
s_barrier
s_add_u32 s65, s78, 1
s_lshl_b32 s65, s65, 11
s_lshl_b32 s66, s5, 2
s_add_u32 s66, s66, s4
s_mul_i32 s66, s66, 114688
s_add_u32 s65, s65, s66
s_add_u32 s65, s65, 8388608
buffer_store_dwordx4 v[104:107], v14, s[28:31], s65 offen sc1
buffer_store_dwordx4 v[108:111], v14, s[28:31], s65 offen offset:1024 sc1
s_mov_b32 s47, 384
s_call_b64 s[72:73], L_EPI
s_add_u32 s65, s79, 1
s_lshl_b32 s65, s65, 11
s_lshl_b32 s66, s5, 2
s_add_u32 s66, s66, s4
s_mul_i32 s66, s66, 114688
s_add_u32 s65, s65, s66
s_add_u32 s65, s65, 8388608
buffer_store_dwordx4 v[104:107], v14, s[28:31], s65 offen sc1
buffer_store_dwordx4 v[108:111], v14, s[28:31], s65 offen offset:1024 sc1
s_waitcnt vmcnt(4)
s_branch L_A_NOD3
L_A_NOD2:
s_mov_b32 s47, 86016
s_mov_b32 s74, 0
s_call_b64 s[72:73], L_DMAKV
s_barrier
s_add_u32 s65, s78, 1
s_lshl_b32 s65, s65, 11
s_lshl_b32 s66, s5, 2
s_add_u32 s66, s66, s4
s_mul_i32 s66, s66, 114688
s_add_u32 s65, s65, s66
s_add_u32 s65, s65, 8388608
buffer_store_dwordx4 v[104:107], v14, s[28:31], s65 offen sc1
buffer_store_dwordx4 v[108:111], v14, s[28:31], s65 offen offset:1024 sc1
s_waitcnt vmcnt(2)
L_A_NOD3:
s_lshl_b32 s101, s83, 3
s_lshl_b32 s66, s4, 1
s_add_u32 s101, s101, s66
s_lshl_b32 s101, s101, 15
s_lshl_b32 s66, s82, 10
s_add_u32 s101, s101, s66
s_add_u32 s101, s101, 16777216
s_add_u32 s65, s101, 32768
v_mov_b32 v76, -1
v_mov_b32 v77, -1
v_mov_b32 v78, -1
v_mov_b32 v79, -1
buffer_store_dwordx4 v[76:79], v14, s[28:31], s101 offen sc1
buffer_store_dwordx4 v[76:79], v14, s[28:31], s65 offen sc1
s_barrier
s_setprio 1
s_mov_b32 s89, 0
L_ATT:
v_mov_b32 v97, v94
v_mov_b32 v98, v95
ds_read_b128 v[224:227], v97
ds_read_b128 v[228:231], v97 offset:1024
ds_read_b128 v[232:235], v98 offset:0
ds_read_b128 v[236:239], v98 offset:512
v_mov_b32 v160, 0
v_mov_b32 v161, 0
v_mov_b32 v162, 0
v_mov_b32 v163, 0
v_mov_b32 v164, 0
v_mov_b32 v165, 0
v_mov_b32 v166, 0
v_mov_b32 v167, 0
v_mov_b32 v168, 0
v_mov_b32 v169, 0
v_mov_b32 v170, 0
v_mov_b32 v171, 0
v_mov_b32 v172, 0
v_mov_b32 v173, 0
v_mov_b32 v174, 0
v_mov_b32 v175, 0
v_mov_b32 v244, 0
v_mov_b32 v245, 0
v_mov_b32 v246, 0
v_mov_b32 v247, 0
s_mov_b32 s86, 0
s_waitcnt lgkmcnt(0)
s_cmp_eq_u32 s89, 0
s_cbranch_scc0 L_ATT_HAVEC
v_mfma_f32_32x32x16_bf16 v[128:143], v[224:227], v[120:123], 0
v_mfma_f32_32x32x16_bf16 v[144:159], v[224:227], v[124:127], 0
v_mov_b32 v176, 0
v_mov_b32 v177, 0
v_mov_b32 v178, 0
v_mov_b32 v179, 0
v_mov_b32 v180, 0
v_mov_b32 v181, 0
v_mov_b32 v182, 0
v_mov_b32 v183, 0
v_mov_b32 v184, 0
v_mov_b32 v185, 0
v_mov_b32 v186, 0
v_mov_b32 v187, 0
v_mov_b32 v188, 0
v_mov_b32 v189, 0
v_mov_b32 v190, 0
v_mov_b32 v191, 0
v_max3_f32 v16, v128, v129, v130
v_max3_f32 v16, v16, v131, v132
v_max3_f32 v16, v16, v133, v134
v_max3_f32 v16, v16, v135, v136
v_max3_f32 v16, v16, v137, v138
v_max3_f32 v16, v16, v139, v140
v_max3_f32 v16, v16, v141, v142
v_max_f32 v16, v16, v143
v_max3_f32 v17, v144, v145, v146
v_max3_f32 v17, v17, v147, v148
v_max3_f32 v17, v17, v149, v150
v_max3_f32 v17, v17, v151, v152
v_max3_f32 v17, v17, v153, v154
v_max3_f32 v17, v17, v155, v156
v_max3_f32 v17, v17, v157, v158
v_max_f32 v17, v17, v159
v_mov_b32 v18, v16
s_nop 1
v_permlane32_swap_b32 v16, v18
v_max_f32 v16, v16, v18
v_sub_f32 v192, 0, v16
v_mov_b32 v193, v192
v_mov_b32 v194, v192
v_mov_b32 v195, v192
v_mov_b32 v196, v192
v_mov_b32 v197, v192
v_mov_b32 v198, v192
v_mov_b32 v199, v192
v_mov_b32 v200, v192
v_mov_b32 v201, v192
v_mov_b32 v202, v192
v_mov_b32 v203, v192
v_mov_b32 v204, v192
v_mov_b32 v205, v192
v_mov_b32 v206, v192
v_mov_b32 v207, v192
s_nop 1
v_mfma_f32_32x32x16_bf16 v[128:143], v[224:227], v[120:123], v[192:207]
v_mov_b32 v18, v17
s_nop 1
v_permlane32_swap_b32 v17, v18
v_max_f32 v17, v17, v18
v_sub_f32 v208, 0, v17
v_mov_b32 v209, v208
v_mov_b32 v210, v208
v_mov_b32 v211, v208
v_mov_b32 v212, v208
v_mov_b32 v213, v208
v_mov_b32 v214, v208
v_mov_b32 v215, v208
v_mov_b32 v216, v208
v_mov_b32 v217, v208
v_mov_b32 v218, v208
v_mov_b32 v219, v208
v_mov_b32 v220, v208
v_mov_b32 v221, v208
v_mov_b32 v222, v208
v_mov_b32 v223, v208
L_ATT_GO:
s_movk_i32 s88, 0x1000
s_mov_b32 s86, 1
s_call_b64 s[72:73], L_ATT_RUN
s_cmp_eq_u32 s89, 0
s_cbranch_scc1 L_ATT_BAR
L_ATT_BARRET:
s_mov_b32 s86, 4
s_call_b64 s[72:73], L_ATT_RUN
s_mov_b32 s88, 0xfffe4000
s_mov_b32 s86, 0
s_call_b64 s[72:73], L_ATT_RUN
s_movk_i32 s88, 0x1000
s_mov_b32 s86, 7
s_call_b64 s[72:73], L_ATT_RUN
s_nop 1
v_smfmac_f32_32x32x32_bf16 v[176:191], v[244:247], v[152:159], v96
s_add_u32 s65, s101, 32768
s_mov_b32 s66, 0x7f000000
v_rcp_f32 v18, v168
v_add_f32 v16, abs(v160), v168
v_mul_f32 v18, v18, v1
v_add_f32 v16, abs(v161), v16
v_add_f32 v16, abs(v162), v16
v_add_f32 v16, abs(v163), v16
v_add_f32 v16, abs(v164), v16
v_add_f32 v16, abs(v165), v16
v_add_f32 v16, abs(v166), v16
v_add_f32 v16, abs(v167), v16
v_mul_f32 v28, v160, v18
v_mul_f32 v29, v161, v18
v_mul_f32 v30, v162, v18
v_mul_f32 v31, v163, v18
v_mul_f32 v32, v164, v18
v_mul_f32 v33, v165, v18
v_mul_f32 v34, v166, v18
v_mul_f32 v35, v167, v18
v_rcp_f32 v19, v184
v_add_f32 v17, abs(v176), v184
v_add_f32 v17, abs(v177), v17
v_add_f32 v17, abs(v178), v17
v_add_f32 v17, abs(v179), v17
v_add_f32 v17, abs(v180), v17
v_add_f32 v17, abs(v181), v17
v_add_f32 v17, abs(v182), v17
v_add_f32 v17, abs(v183), v17
v_add_f32 v16, v16, v17
v_cmp_ngt_f32 vcc, s66, v16
s_cbranch_vccnz L_ATT_FB
L_ATT_OK:
v_cvt_pk_bf16_f32 v20, v28, v29
v_cvt_pk_bf16_f32 v21, v30, v31
v_cvt_pk_bf16_f32 v22, v32, v33
v_cvt_pk_bf16_f32 v23, v34, v35
v_mul_f32 v19, v19, v2
v_min_u32 v20, -2, v20
v_min_u32 v21, -2, v21
v_min_u32 v22, -2, v22
v_min_u32 v23, -2, v23
buffer_store_dwordx4 v[20:23], v14, s[28:31], s101 offen sc1
v_mul_f32 v36, v176, v19
v_mul_f32 v37, v177, v19
v_mul_f32 v38, v178, v19
v_mul_f32 v39, v179, v19
v_mul_f32 v40, v180, v19
v_mul_f32 v41, v181, v19
v_mul_f32 v42, v182, v19
v_mul_f32 v43, v183, v19
v_cvt_pk_bf16_f32 v24, v36, v37
v_cvt_pk_bf16_f32 v25, v38, v39
v_cvt_pk_bf16_f32 v26, v40, v41
v_cvt_pk_bf16_f32 v27, v42, v43
v_min_u32 v24, -2, v24
v_min_u32 v25, -2, v25
v_min_u32 v26, -2, v26
v_min_u32 v27, -2, v27
buffer_store_dwordx4 v[24:27], v14, s[28:31], s65 offen sc1
s_barrier
s_endpgm
L_ATT_BAR:
s_waitcnt vmcnt(0)
s_barrier
s_lshl_b32 s65, s83, 2
s_add_u32 s65, s65, s4
s_lshl_b32 s65, s65, 5
s_add_u32 s65, s65, s82
s_lshl_b32 s65, s65, 6
s_add_u32 s65, s65, 20054016
v_mov_b32 v16, s64
v_mov_b32 v17, 0
buffer_store_dword v16, v17, s[28:31], s65 offen sc1

s_branch L_ATT_BARRET
L_ATT_FB:
s_cmp_eq_u32 s89, 0
s_cbranch_scc0 L_ATT_OK
s_mov_b32 s89, 1
s_mov_b32 s86, 0
v_mov_b32 v97, v94
v_mov_b32 v16, 0xff800000
v_mov_b32 v17, 0xff800000
L_FB_LOOP:
ds_read_b128 v[224:227], v97
s_movk_i32 s88, 0x400
s_cmp_eq_u32 s86, 31
s_cmov_b32 s88, 0xfffe3400
s_waitcnt lgkmcnt(0)
v_mfma_f32_32x32x16_bf16 v[128:143], v[224:227], v[120:123], 0
v_mfma_f32_32x32x16_bf16 v[144:159], v[224:227], v[124:127], 0
v_add_u32 v97, s88, v97
s_nop 10
v_max3_f32 v16, v16, v128, v129
v_max3_f32 v16, v16, v130, v131
v_max3_f32 v16, v16, v132, v133
v_max3_f32 v16, v16, v134, v135
v_max3_f32 v16, v16, v136, v137
v_max3_f32 v16, v16, v138, v139
v_max3_f32 v16, v16, v140, v141
v_max3_f32 v16, v16, v142, v143
v_max3_f32 v17, v17, v144, v145
v_max3_f32 v17, v17, v146, v147
v_max3_f32 v17, v17, v148, v149
v_max3_f32 v17, v17, v150, v151
v_max3_f32 v17, v17, v152, v153
v_max3_f32 v17, v17, v154, v155
v_max3_f32 v17, v17, v156, v157
v_max3_f32 v17, v17, v158, v159
s_add_u32 s86, s86, 1
s_cmp_lt_u32 s86, 64
s_cbranch_scc1 L_FB_LOOP
v_mov_b32 v18, v16
s_nop 1
v_permlane32_swap_b32 v16, v18
v_max_f32 v16, v16, v18
v_sub_f32 v192, 0, v16
v_mov_b32 v193, v192
v_mov_b32 v194, v192
v_mov_b32 v195, v192
v_mov_b32 v196, v192
v_mov_b32 v197, v192
v_mov_b32 v198, v192
v_mov_b32 v199, v192
v_mov_b32 v200, v192
v_mov_b32 v201, v192
v_mov_b32 v202, v192
v_mov_b32 v203, v192
v_mov_b32 v204, v192
v_mov_b32 v205, v192
v_mov_b32 v206, v192
v_mov_b32 v207, v192
v_mov_b32 v18, v17
s_nop 1
v_permlane32_swap_b32 v17, v18
v_max_f32 v17, v17, v18
v_sub_f32 v208, 0, v17
v_mov_b32 v209, v208
v_mov_b32 v210, v208
v_mov_b32 v211, v208
v_mov_b32 v212, v208
v_mov_b32 v213, v208
v_mov_b32 v214, v208
v_mov_b32 v215, v208
v_mov_b32 v216, v208
v_mov_b32 v217, v208
v_mov_b32 v218, v208
v_mov_b32 v219, v208
v_mov_b32 v220, v208
v_mov_b32 v221, v208
v_mov_b32 v222, v208
v_mov_b32 v223, v208
s_branch L_ATT
L_ATT_HAVEC:
v_mfma_f32_32x32x16_bf16 v[128:143], v[224:227], v[120:123], v[192:207]
v_mov_b32 v176, 0
v_mov_b32 v177, 0
v_mov_b32 v178, 0
v_mov_b32 v179, 0
v_mov_b32 v180, 0
v_mov_b32 v181, 0
v_mov_b32 v182, 0
v_mov_b32 v183, 0
v_mov_b32 v184, 0
v_mov_b32 v185, 0
v_mov_b32 v186, 0
v_mov_b32 v187, 0
v_mov_b32 v188, 0
v_mov_b32 v189, 0
v_mov_b32 v190, 0
v_mov_b32 v191, 0
s_branch L_ATT_GO
L_G:
v_and_b32 v1, 31, v0
v_lshrrev_b32 v2, 5, v0
v_bfe_u32 v3, v0, 1, 3
v_xor_b32 v2, v2, v3
v_lshlrev_b32 v2, 4, v2
v_lshl_add_u32 v2, v1, 7, v2
s_lshl_b32 s65, s4, 12
v_add_u32 v4, s65, v2
v_xor_b32 v5, 32, v4
v_xor_b32 v6, 64, v4
v_xor_b32 v7, 0x60, v4
v_lshrrev_b32 v1, 5, v0
v_lshlrev_b32 v1, 9, v1
v_bfe_u32 v2, v0, 2, 2
v_lshl_add_u32 v1, v2, 6, v1
v_bfe_u32 v2, v0, 4, 1
v_lshl_add_u32 v1, v2, 5, v1
v_and_b32 v2, 3, v0
v_lshl_add_u32 v1, v2, 3, v1
v_add_u32 v8, 16384, v1
v_add_u32 v9, 73728, v1
v_add_u32 v10, 131072, v1
v_lshrrev_b32 v1, 5, v0
v_lshlrev_b32 v1, 10, v1
v_bfe_u32 v2, v0, 2, 2
v_lshl_add_u32 v1, v2, 7, v1
v_bfe_u32 v2, v0, 4, 1
v_lshl_add_u32 v1, v2, 5, v1
v_and_b32 v2, 1, v0
v_lshl_add_u32 v1, v2, 4, v1
v_bfe_u32 v2, v0, 1, 1
v_lshl_add_u32 v1, v2, 3, v1
v_bfe_u32 v2, v0, 3, 1
v_lshlrev_b32 v2, 6, v2
v_xor_b32 v102, v1, v2
v_lshrrev_b32 v2, 5, v0
v_lshlrev_b32 v2, 5, v2
v_add_u32 v100, 157696, v2
v_mov_b32 v101, 0xc0135761
v_lshlrev_b32 v14, 4, v0
s_lshr_b32 s65, s6, 2
s_mul_i32 s65, s65, 14
s_and_b32 s66, s6, 3
s_lshl_b32 s67, s66, 3
s_lshr_b32 s68, 0x0a080400, s67
s_and_b32 s68, s68, 0xff
s_add_u32 s78, s65, s68
s_lshr_b32 s68, 0x0c060602, s67
s_and_b32 s68, s68, 0xff
s_add_u32 s79, s65, s68
s_cmp_lg_u32 s66, 2
s_cselect_b32 s80, 1, 0
s_cmp_lg_u32 s66, 1
s_cselect_b32 s81, 1, 0
v_and_b32 v1, 3, v0
v_bfe_u32 v2, v0, 2, 1
v_lshl_or_b32 v1, v2, 3, v1
v_bfe_u32 v2, v0, 3, 1
v_lshl_or_b32 v1, v2, 2, v1
v_lshlrev_b32 v1, 4, v1
v_bfe_u32 v2, v0, 4, 1
v_lshrrev_b32 v3, 5, v0
v_lshl_or_b32 v11, v2, 8, v1
v_lshl_or_b32 v11, v3, 9, v11
v_lshl_or_b32 v15, v2, 16, v1
v_lshl_or_b32 v15, v3, 8, v15
v_lshrrev_b32 v1, 2, v0
v_lshlrev_b32 v1, 7, v1
v_and_b32 v2, 3, v0
v_lshl_add_u32 v1, v2, 3, v1
v_bfe_u32 v2, v0, 3, 1
v_lshlrev_b32 v2, 6, v2
v_xor_b32 v1, v1, v2
s_lshl_b32 s65, s4, 5
v_xor_b32 v103, s65, v1
v_lshrrev_b32 v1, 3, v0
v_mul_u32_u24 v3, 3584, v1
v_bfe_u32 v1, v0, 4, 1
v_lshlrev_b32 v1, 2, v1
v_xor_b32 v1, v1, v0
v_and_b32 v1, 7, v1
v_lshl_add_u32 v117, v1, 4, v3
v_add_u32 v119, 27648, v117
v_and_b32 v1, 31, v0
v_lshlrev_b32 v1, 4, v1
s_lshl_b32 s65, s4, 9
s_add_u32 s65, s65, 158976
v_add_u32 v122, s65, v1
s_waitcnt lgkmcnt(0)
s_mov_b32 s28, s62
s_and_b32 s29, s63, 0xffff
s_mov_b32 s30, 0x1800000
s_mov_b32 s31, 0x20000
s_mov_b32 s16, s48
s_and_b32 s17, s49, 0xffff
s_mov_b32 s18, 0x1c0000
s_mov_b32 s19, 0x20000
s_cmp_eq_u32 s4, 3
s_cbranch_scc0 L_NOPF
s_getpc_b64 s[70:71]
L_PFBASE:
s_sub_u32 s70, s70, L_PFBASE-gated_mix__mha_block__mixer_channel_mlp__prompt_kernel
s_subb_u32 s71, s71, 0
s_lshr_b32 s65, s2, 3
s_lshl_b32 s65, s65, 10
v_lshl_add_u32 v2, v0, 4, s65
s_mov_b32 s65, L_CODE_END-gated_mix__mha_block__mixer_channel_mlp__prompt_kernel-4
v_min_u32 v2, s65, v2
v_mov_b32 v3, s71
v_add_co_u32 v2, vcc, s70, v2
s_nop 1
v_addc_co_u32 v3, vcc, 0, v3, vcc
global_load_dword v127, v[2:3], off
L_NOPF:
s_or_b32 s65, s2, s4
s_cmp_eq_u32 s65, 0
s_cbranch_scc0 L_G_TDONE
v_mov_b32 v24, 20185088
buffer_load_dword v25, v24, s[28:31], 0 offen sc1
s_waitcnt vmcnt(0)
v_add_u32 v25, 1, v25
v_max_u32 v25, 1, v25
s_mov_b32 s36, s60
s_and_b32 s37, s61, 0xffff
s_mov_b32 s38, 0x100
s_mov_b32 s39, 0x20000
v_mov_b32 v26, 0
buffer_store_dword v25, v26, s[36:39], 0 offen sc1
buffer_store_dword v25, v24, s[28:31], 0 offen sc1
L_G_TDONE:
s_mul_i32 s65, s6, 3
s_add_u32 s65, s65, 0
s_lshr_b32 s86, s65, 4
s_and_b32 s65, s65, 15
s_lshl_b32 s65, s65, 17
s_lshl_b32 s67, s86, 21
s_add_u32 s65, s65, s67
s_lshl_b32 s67, s5, 2
s_add_u32 s67, s67, s4
s_lshl_b32 s67, s67, 10
s_add_u32 s8, s65, s67
s_mov_b32 s67, 65536
s_cmp_eq_u32 s86, 1
s_cselect_b64 vcc, -1, 0
s_cmp_eq_u32 s86, 2
s_cselect_b64 s[70:71], -1, 0
s_cmov_b32 s67, 512
s_add_u32 s9, s67, s8
v_cndmask_b32 v16, v14, v11, vcc
v_cndmask_b32 v16, v16, v15, s[70:71]
s_mul_i32 s65, s6, 3
s_add_u32 s65, s65, 1
s_lshr_b32 s87, s65, 4
s_and_b32 s65, s65, 15
s_lshl_b32 s65, s65, 17
s_lshl_b32 s67, s87, 21
s_add_u32 s65, s65, s67
s_lshl_b32 s67, s5, 2
s_add_u32 s67, s67, s4
s_lshl_b32 s67, s67, 10
s_add_u32 s10, s65, s67
s_mov_b32 s67, 65536
s_cmp_eq_u32 s87, 1
s_cselect_b64 vcc, -1, 0
s_cmp_eq_u32 s87, 2
s_cselect_b64 s[70:71], -1, 0
s_cmov_b32 s67, 512
s_add_u32 s11, s67, s10
v_cndmask_b32 v17, v14, v11, vcc
v_cndmask_b32 v17, v17, v15, s[70:71]
s_mul_i32 s65, s6, 3
s_add_u32 s65, s65, 2
s_lshr_b32 s88, s65, 4
s_and_b32 s65, s65, 15
s_lshl_b32 s65, s65, 17
s_lshl_b32 s67, s88, 21
s_add_u32 s65, s65, s67
s_lshl_b32 s67, s5, 2
s_add_u32 s67, s67, s4
s_lshl_b32 s67, s67, 10
s_add_u32 s12, s65, s67
s_mov_b32 s67, 65536
s_cmp_eq_u32 s88, 1
s_cselect_b64 vcc, -1, 0
s_cmp_eq_u32 s88, 2
s_cselect_b64 s[70:71], -1, 0
s_cmov_b32 s67, 512
s_add_u32 s13, s67, s12
v_cndmask_b32 v18, v14, v11, vcc
v_cndmask_b32 v18, v18, v15, s[70:71]
v_mov_b32 v11, v16
v_mov_b32 v15, v17
v_mov_b32 v123, v18
s_lshr_b32 s65, s84, 1
s_lshl_b32 s65, s65, 10
s_add_u32 s65, s65, 19988480
v_and_b32 v1, 15, v0
v_lshlrev_b32 v1, 6, v1
v_add_u32 v120, s65, v1
v_lshrrev_b32 v1, 3, v0
v_bfe_u32 v2, v0, 4, 1
v_lshlrev_b32 v2, 2, v2
v_xor_b32 v2, v2, v0
v_and_b32 v2, 7, v2
v_lshlrev_b32 v2, 4, v2
v_lshl_add_u32 v112, v1, 10, v2
v_add_u32 v113, 7168, v112
v_lshrrev_b32 v1, 5, v0
v_lshlrev_b32 v1, 10, v1
v_bfe_u32 v2, v0, 2, 2
v_lshl_add_u32 v1, v2, 7, v1
v_bfe_u32 v2, v0, 4, 1
v_lshl_add_u32 v1, v2, 5, v1
v_and_b32 v2, 1, v0
v_lshl_add_u32 v1, v2, 4, v1
v_bfe_u32 v2, v0, 1, 1
v_lshl_add_u32 v1, v2, 3, v1
v_bfe_u32 v2, v0, 3, 1
v_lshlrev_b32 v2, 6, v2
v_xor_b32 v1, v1, v2
s_mul_i32 s76, s4, 6144
s_add_u32 s76, s76, 65536
s_cmp_eq_u32 s4, 3
s_cmov_b32 s76, 155648
s_and_b32 s65, s4, 1
s_lshl_b32 s65, s65, 6
v_xor_b32 v1, s65, v1
v_add_u32 v114, s76, v1
v_xor_b32 v115, 64, v114
s_lshr_b32 s65, s4, 1
s_mul_i32 s66, s65, 114688
s_sub_u32 s67, 114688, s66
v_add_u32 v116, s66, v14
v_add_u32 v126, s67, v14
s_mul_i32 s94, s4, 458752
s_lshl_b32 s66, s85, 7
s_add_u32 s94, s94, s66
s_mul_i32 s95, s84, 229376
s_mul_i32 s66, s4, 28672
s_add_u32 s95, s95, s66
s_add_u32 s95, s95, 8388608
v_and_b32 v1, 31, v0
v_lshlrev_b32 v1, 2, v1
s_lshl_b32 s65, s65, 7
v_add_u32 v121, s65, v1
s_mov_b32 s36, s60
s_and_b32 s37, s61, 0xffff
s_mov_b32 s38, 0x100
s_mov_b32 s39, 0x20000
s_mov_b32 s20, s52
s_and_b32 s21, s53, 0xffff
s_mov_b32 s22, 0x1c0000
s_mov_b32 s23, 0x20000
s_mov_b32 s24, s44
s_and_b32 s25, s45, 0xffff
s_mov_b32 s26, 0x80000
s_mov_b32 s27, 0x20000
s_mov_b32 s32, s58
s_and_b32 s33, s59, 0xffff
s_mov_b32 s34, 0x200000
s_mov_b32 s35, 0x20000
s_waitcnt lgkmcnt(0)
s_barrier
s_cmp_ge_u32 s6, 11
s_cbranch_scc1 L_G_P1_2
s_cmp_eq_u32 s6, 10
s_cbranch_scc1 L_G_P1_1
ds_read_b64_tr_b16 v[64:65], v8 offset:0
ds_read_b64_tr_b16 v[66:67], v8 offset:256
ds_read_b64_tr_b16 v[68:69], v8 offset:1024
ds_read_b64_tr_b16 v[70:71], v8 offset:1280
ds_read_b64_tr_b16 v[72:73], v8 offset:2048
ds_read_b64_tr_b16 v[74:75], v8 offset:2304
ds_read_b128 v[128:131], v4 offset:0
ds_read_b64_tr_b16 v[76:77], v8 offset:3072
ds_read_b64_tr_b16 v[78:79], v8 offset:3328
ds_read_b64_tr_b16 v[80:81], v8 offset:4096
ds_read_b64_tr_b16 v[82:83], v8 offset:4352
ds_read_b64_tr_b16 v[84:85], v8 offset:5120
ds_read_b64_tr_b16 v[86:87], v8 offset:5376
ds_read_b128 v[132:135], v5 offset:0
s_waitcnt lgkmcnt(7)
v_mfma_f32_32x32x16_bf16 v[16:31], v[64:67], v[128:131], 0
ds_read_b64_tr_b16 v[88:89], v8 offset:6144
ds_read_b64_tr_b16 v[90:91], v8 offset:6400
ds_read_b64_tr_b16 v[92:93], v8 offset:7168
v_mfma_f32_32x32x16_bf16 v[32:47], v[68:71], v[128:131], 0
ds_read_b64_tr_b16 v[94:95], v8 offset:7424
ds_read_b64_tr_b16 v[96:97], v8 offset:8192
v_mfma_f32_32x32x16_bf16 v[48:63], v[72:75], v[128:131], 0
ds_read_b64_tr_b16 v[98:99], v8 offset:8448
ds_read_b128 v[136:139], v6 offset:0
v_mfma_f32_4x4x4_16b_bf16 v[104:107], v[128:129], v[128:129], 0
v_mfma_f32_4x4x4_16b_bf16 v[108:111], v[130:131], v[130:131], 0
s_waitcnt lgkmcnt(7)
v_mfma_f32_32x32x16_bf16 v[16:31], v[76:79], v[132:135], v[16:31]
ds_read_b64_tr_b16 v[64:65], v8 offset:9216
ds_read_b64_tr_b16 v[66:67], v8 offset:9472
ds_read_b64_tr_b16 v[68:69], v8 offset:10240
v_mfma_f32_32x32x16_bf16 v[32:47], v[80:83], v[132:135], v[32:47]
ds_read_b64_tr_b16 v[70:71], v8 offset:10496
ds_read_b64_tr_b16 v[72:73], v8 offset:11264
v_mfma_f32_32x32x16_bf16 v[48:63], v[84:87], v[132:135], v[48:63]
ds_read_b64_tr_b16 v[74:75], v8 offset:11520
ds_read_b128 v[140:143], v7 offset:0
v_mfma_f32_4x4x4_16b_bf16 v[104:107], v[132:133], v[132:133], v[104:107]
v_mfma_f32_4x4x4_16b_bf16 v[108:111], v[134:135], v[134:135], v[108:111]
s_waitcnt lgkmcnt(0)
v_mfma_f32_32x32x16_bf16 v[16:31], v[88:91], v[136:139], v[16:31]
v_mfma_f32_32x32x16_bf16 v[32:47], v[92:95], v[136:139], v[32:47]
s_barrier
ds_read_b64_tr_b16 v[76:77], v8 offset:28672
ds_read_b64_tr_b16 v[78:79], v8 offset:28928
ds_read_b64_tr_b16 v[80:81], v8 offset:29696
ds_read_b64_tr_b16 v[82:83], v8 offset:29952
v_mfma_f32_32x32x16_bf16 v[48:63], v[96:99], v[136:139], v[48:63]
ds_read_b64_tr_b16 v[84:85], v8 offset:30720
ds_read_b64_tr_b16 v[86:87], v8 offset:30976
ds_read_b128 v[144:147], v4 offset:28672
v_mfma_f32_4x4x4_16b_bf16 v[104:107], v[136:137], v[136:137], v[104:107]
v_mfma_f32_4x4x4_16b_bf16 v[108:111], v[138:139], v[138:139], v[108:111]
s_waitcnt lgkmcnt(7)
v_mfma_f32_32x32x16_bf16 v[16:31], v[64:67], v[140:143], v[16:31]
ds_read_b64_tr_b16 v[88:89], v8 offset:31744
ds_read_b64_tr_b16 v[90:91], v8 offset:32000
ds_read_b64_tr_b16 v[92:93], v8 offset:32768
v_mfma_f32_32x32x16_bf16 v[32:47], v[68:71], v[140:143], v[32:47]
ds_read_b64_tr_b16 v[94:95], v8 offset:33024
ds_read_b64_tr_b16 v[96:97], v8 offset:33792
v_mfma_f32_32x32x16_bf16 v[48:63], v[72:75], v[140:143], v[48:63]
ds_read_b64_tr_b16 v[98:99], v8 offset:34048
ds_read_b128 v[148:151], v5 offset:28672
v_mfma_f32_4x4x4_16b_bf16 v[104:107], v[140:141], v[140:141], v[104:107]
v_mfma_f32_4x4x4_16b_bf16 v[108:111], v[142:143], v[142:143], v[108:111]
s_waitcnt lgkmcnt(7)
v_mfma_f32_32x32x16_bf16 v[16:31], v[76:79], v[144:147], v[16:31]
ds_read_b64_tr_b16 v[64:65], v8 offset:34816
ds_read_b64_tr_b16 v[66:67], v8 offset:35072
ds_read_b64_tr_b16 v[68:69], v8 offset:35840
v_mfma_f32_32x32x16_bf16 v[32:47], v[80:83], v[144:147], v[32:47]
ds_read_b64_tr_b16 v[70:71], v8 offset:36096
ds_read_b64_tr_b16 v[72:73], v8 offset:36864
v_mfma_f32_32x32x16_bf16 v[48:63], v[84:87], v[144:147], v[48:63]
ds_read_b64_tr_b16 v[74:75], v8 offset:37120
ds_read_b128 v[152:155], v6 offset:28672
v_mfma_f32_4x4x4_16b_bf16 v[104:107], v[144:145], v[144:145], v[104:107]
v_mfma_f32_4x4x4_16b_bf16 v[108:111], v[146:147], v[146:147], v[108:111]
s_waitcnt lgkmcnt(7)
v_mfma_f32_32x32x16_bf16 v[16:31], v[88:91], v[148:151], v[16:31]
ds_read_b64_tr_b16 v[76:77], v8 offset:37888
ds_read_b64_tr_b16 v[78:79], v8 offset:38144
ds_read_b64_tr_b16 v[80:81], v8 offset:38912
v_mfma_f32_32x32x16_bf16 v[32:47], v[92:95], v[148:151], v[32:47]
ds_read_b64_tr_b16 v[82:83], v8 offset:39168
ds_read_b64_tr_b16 v[84:85], v8 offset:39936
v_mfma_f32_32x32x16_bf16 v[48:63], v[96:99], v[148:151], v[48:63]
ds_read_b64_tr_b16 v[86:87], v8 offset:40192
ds_read_b128 v[156:159], v7 offset:28672
v_mfma_f32_4x4x4_16b_bf16 v[104:107], v[148:149], v[148:149], v[104:107]
v_mfma_f32_4x4x4_16b_bf16 v[108:111], v[150:151], v[150:151], v[108:111]
s_waitcnt lgkmcnt(0)
v_mfma_f32_32x32x16_bf16 v[16:31], v[64:67], v[152:155], v[16:31]
v_mfma_f32_32x32x16_bf16 v[32:47], v[68:71], v[152:155], v[32:47]
s_barrier
ds_read_b64_tr_b16 v[88:89], v9 offset:0
ds_read_b64_tr_b16 v[90:91], v9 offset:256
ds_read_b64_tr_b16 v[92:93], v9 offset:1024
ds_read_b64_tr_b16 v[94:95], v9 offset:1280
v_mfma_f32_32x32x16_bf16 v[48:63], v[72:75], v[152:155], v[48:63]
ds_read_b64_tr_b16 v[96:97], v9 offset:2048
ds_read_b64_tr_b16 v[98:99], v9 offset:2304
ds_read_b128 v[160:163], v4 offset:57344
v_mfma_f32_4x4x4_16b_bf16 v[104:107], v[152:153], v[152:153], v[104:107]
v_mfma_f32_4x4x4_16b_bf16 v[108:111], v[154:155], v[154:155], v[108:111]
s_waitcnt lgkmcnt(7)
v_mfma_f32_32x32x16_bf16 v[16:31], v[76:79], v[156:159], v[16:31]
ds_read_b64_tr_b16 v[64:65], v9 offset:3072
ds_read_b64_tr_b16 v[66:67], v9 offset:3328
ds_read_b64_tr_b16 v[68:69], v9 offset:4096
v_mfma_f32_32x32x16_bf16 v[32:47], v[80:83], v[156:159], v[32:47]
ds_read_b64_tr_b16 v[70:71], v9 offset:4352
ds_read_b64_tr_b16 v[72:73], v9 offset:5120
v_mfma_f32_32x32x16_bf16 v[48:63], v[84:87], v[156:159], v[48:63]
ds_read_b64_tr_b16 v[74:75], v9 offset:5376
ds_read_b128 v[164:167], v5 offset:57344
v_mfma_f32_4x4x4_16b_bf16 v[104:107], v[156:157], v[156:157], v[104:107]
v_mfma_f32_4x4x4_16b_bf16 v[108:111], v[158:159], v[158:159], v[108:111]
s_waitcnt lgkmcnt(7)
v_mfma_f32_32x32x16_bf16 v[16:31], v[88:91], v[160:163], v[16:31]
ds_read_b64_tr_b16 v[76:77], v9 offset:6144
ds_read_b64_tr_b16 v[78:79], v9 offset:6400
ds_read_b64_tr_b16 v[80:81], v9 offset:7168
v_mfma_f32_32x32x16_bf16 v[32:47], v[92:95], v[160:163], v[32:47]
ds_read_b64_tr_b16 v[82:83], v9 offset:7424
ds_read_b64_tr_b16 v[84:85], v9 offset:8192
v_mfma_f32_32x32x16_bf16 v[48:63], v[96:99], v[160:163], v[48:63]
ds_read_b64_tr_b16 v[86:87], v9 offset:8448
ds_read_b128 v[168:171], v6 offset:57344
v_mfma_f32_4x4x4_16b_bf16 v[104:107], v[160:161], v[160:161], v[104:107]
v_mfma_f32_4x4x4_16b_bf16 v[108:111], v[162:163], v[162:163], v[108:111]
s_waitcnt lgkmcnt(7)
s_cmp_eq_u32 s4, 0
s_cbranch_scc0 L_G_NOEP0
v_mov_b32 v1, 0
buffer_load_dword v125, v1, s[36:39], 0 offen sc1
L_G_NOEP0:
v_mfma_f32_32x32x16_bf16 v[16:31], v[64:67], v[164:167], v[16:31]
ds_read_b64_tr_b16 v[88:89], v9 offset:9216
ds_read_b64_tr_b16 v[90:91], v9 offset:9472
ds_read_b64_tr_b16 v[92:93], v9 offset:10240
v_mfma_f32_32x32x16_bf16 v[32:47], v[68:71], v[164:167], v[32:47]
ds_read_b64_tr_b16 v[94:95], v9 offset:10496
ds_read_b64_tr_b16 v[96:97], v9 offset:11264
v_mfma_f32_32x32x16_bf16 v[48:63], v[72:75], v[164:167], v[48:63]
ds_read_b64_tr_b16 v[98:99], v9 offset:11520
ds_read_b128 v[172:175], v7 offset:57344
v_mfma_f32_4x4x4_16b_bf16 v[104:107], v[164:165], v[164:165], v[104:107]
v_mfma_f32_4x4x4_16b_bf16 v[108:111], v[166:167], v[166:167], v[108:111]
s_waitcnt lgkmcnt(0)
v_mfma_f32_32x32x16_bf16 v[16:31], v[76:79], v[168:171], v[16:31]
v_mfma_f32_32x32x16_bf16 v[32:47], v[80:83], v[168:171], v[32:47]
s_barrier
v_add_u32 v4, 0x10000, v4
v_add_u32 v5, 0x10000, v5
v_add_u32 v6, 0x10000, v6
v_add_u32 v7, 0x10000, v7
ds_read_b64_tr_b16 v[64:65], v9 offset:28672
ds_read_b64_tr_b16 v[66:67], v9 offset:28928
ds_read_b64_tr_b16 v[68:69], v9 offset:29696
ds_read_b64_tr_b16 v[70:71], v9 offset:29952
v_mfma_f32_32x32x16_bf16 v[48:63], v[84:87], v[168:171], v[48:63]
ds_read_b64_tr_b16 v[72:73], v9 offset:30720
ds_read_b64_tr_b16 v[74:75], v9 offset:30976
ds_read_b128 v[176:179], v4 offset:20480
v_mfma_f32_4x4x4_16b_bf16 v[104:107], v[168:169], v[168:169], v[104:107]
v_mfma_f32_4x4x4_16b_bf16 v[108:111], v[170:171], v[170:171], v[108:111]
s_waitcnt lgkmcnt(7)
v_mfma_f32_32x32x16_bf16 v[16:31], v[88:91], v[172:175], v[16:31]
ds_read_b64_tr_b16 v[76:77], v9 offset:31744
ds_read_b64_tr_b16 v[78:79], v9 offset:32000
ds_read_b64_tr_b16 v[80:81], v9 offset:32768
v_mfma_f32_32x32x16_bf16 v[32:47], v[92:95], v[172:175], v[32:47]
ds_read_b64_tr_b16 v[82:83], v9 offset:33024
ds_read_b64_tr_b16 v[84:85], v9 offset:33792
v_mfma_f32_32x32x16_bf16 v[48:63], v[96:99], v[172:175], v[48:63]
ds_read_b64_tr_b16 v[86:87], v9 offset:34048
ds_read_b128 v[180:183], v5 offset:20480
v_mfma_f32_4x4x4_16b_bf16 v[104:107], v[172:173], v[172:173], v[104:107]
v_mfma_f32_4x4x4_16b_bf16 v[108:111], v[174:175], v[174:175], v[108:111]
s_waitcnt lgkmcnt(7)
v_mfma_f32_32x32x16_bf16 v[16:31], v[64:67], v[176:179], v[16:31]
ds_read_b64_tr_b16 v[88:89], v9 offset:34816
ds_read_b64_tr_b16 v[90:91], v9 offset:35072
ds_read_b64_tr_b16 v[92:93], v9 offset:35840
v_mfma_f32_32x32x16_bf16 v[32:47], v[68:71], v[176:179], v[32:47]
ds_read_b64_tr_b16 v[94:95], v9 offset:36096
ds_read_b64_tr_b16 v[96:97], v9 offset:36864
v_mfma_f32_32x32x16_bf16 v[48:63], v[72:75], v[176:179], v[48:63]
ds_read_b64_tr_b16 v[98:99], v9 offset:37120
ds_read_b128 v[184:187], v6 offset:20480
v_mfma_f32_4x4x4_16b_bf16 v[104:107], v[176:177], v[176:177], v[104:107]
v_mfma_f32_4x4x4_16b_bf16 v[108:111], v[178:179], v[178:179], v[108:111]
s_waitcnt lgkmcnt(7)
v_mfma_f32_32x32x16_bf16 v[16:31], v[76:79], v[180:183], v[16:31]
ds_read_b64_tr_b16 v[64:65], v9 offset:37888
ds_read_b64_tr_b16 v[66:67], v9 offset:38144
ds_read_b64_tr_b16 v[68:69], v9 offset:38912
v_mfma_f32_32x32x16_bf16 v[32:47], v[80:83], v[180:183], v[32:47]
ds_read_b64_tr_b16 v[70:71], v9 offset:39168
ds_read_b64_tr_b16 v[72:73], v9 offset:39936
v_mfma_f32_32x32x16_bf16 v[48:63], v[84:87], v[180:183], v[48:63]
ds_read_b64_tr_b16 v[74:75], v9 offset:40192
ds_read_b128 v[188:191], v7 offset:20480
v_mfma_f32_4x4x4_16b_bf16 v[104:107], v[180:181], v[180:181], v[104:107]
v_mfma_f32_4x4x4_16b_bf16 v[108:111], v[182:183], v[182:183], v[108:111]
s_waitcnt lgkmcnt(0)
v_mfma_f32_32x32x16_bf16 v[16:31], v[88:91], v[184:187], v[16:31]
v_mfma_f32_32x32x16_bf16 v[32:47], v[92:95], v[184:187], v[32:47]
s_barrier
ds_read_b64_tr_b16 v[76:77], v10 offset:0
ds_read_b64_tr_b16 v[78:79], v10 offset:256
ds_read_b64_tr_b16 v[80:81], v10 offset:1024
ds_read_b64_tr_b16 v[82:83], v10 offset:1280
v_mfma_f32_32x32x16_bf16 v[48:63], v[96:99], v[184:187], v[48:63]
ds_read_b64_tr_b16 v[84:85], v10 offset:2048
ds_read_b64_tr_b16 v[86:87], v10 offset:2304
ds_read_b128 v[192:195], v4 offset:49152
v_mfma_f32_4x4x4_16b_bf16 v[104:107], v[184:185], v[184:185], v[104:107]
v_mfma_f32_4x4x4_16b_bf16 v[108:111], v[186:187], v[186:187], v[108:111]
s_waitcnt lgkmcnt(7)
v_mfma_f32_32x32x16_bf16 v[16:31], v[64:67], v[188:191], v[16:31]
ds_read_b64_tr_b16 v[88:89], v10 offset:3072
ds_read_b64_tr_b16 v[90:91], v10 offset:3328
ds_read_b64_tr_b16 v[92:93], v10 offset:4096
v_mfma_f32_32x32x16_bf16 v[32:47], v[68:71], v[188:191], v[32:47]
ds_read_b64_tr_b16 v[94:95], v10 offset:4352
ds_read_b64_tr_b16 v[96:97], v10 offset:5120
v_mfma_f32_32x32x16_bf16 v[48:63], v[72:75], v[188:191], v[48:63]
ds_read_b64_tr_b16 v[98:99], v10 offset:5376
ds_read_b128 v[196:199], v5 offset:49152
v_mfma_f32_4x4x4_16b_bf16 v[104:107], v[188:189], v[188:189], v[104:107]
v_mfma_f32_4x4x4_16b_bf16 v[108:111], v[190:191], v[190:191], v[108:111]
s_waitcnt lgkmcnt(7)
v_mfma_f32_32x32x16_bf16 v[16:31], v[76:79], v[192:195], v[16:31]
ds_read_b64_tr_b16 v[64:65], v10 offset:6144
ds_read_b64_tr_b16 v[66:67], v10 offset:6400
ds_read_b64_tr_b16 v[68:69], v10 offset:7168
v_mfma_f32_32x32x16_bf16 v[32:47], v[80:83], v[192:195], v[32:47]
ds_read_b64_tr_b16 v[70:71], v10 offset:7424
ds_read_b64_tr_b16 v[72:73], v10 offset:8192
v_mfma_f32_32x32x16_bf16 v[48:63], v[84:87], v[192:195], v[48:63]
ds_read_b64_tr_b16 v[74:75], v10 offset:8448
ds_read_b128 v[200:203], v6 offset:49152
v_mfma_f32_4x4x4_16b_bf16 v[104:107], v[192:193], v[192:193], v[104:107]
v_mfma_f32_4x4x4_16b_bf16 v[108:111], v[194:195], v[194:195], v[108:111]
s_waitcnt lgkmcnt(7)
v_mfma_f32_32x32x16_bf16 v[16:31], v[88:91], v[196:199], v[16:31]
ds_read_b64_tr_b16 v[76:77], v10 offset:9216
ds_read_b64_tr_b16 v[78:79], v10 offset:9472
ds_read_b64_tr_b16 v[80:81], v10 offset:10240
v_mfma_f32_32x32x16_bf16 v[32:47], v[92:95], v[196:199], v[32:47]
ds_read_b64_tr_b16 v[82:83], v10 offset:10496
ds_read_b64_tr_b16 v[84:85], v10 offset:11264
v_mfma_f32_32x32x16_bf16 v[48:63], v[96:99], v[196:199], v[48:63]
ds_read_b64_tr_b16 v[86:87], v10 offset:11520
ds_read_b128 v[204:207], v7 offset:49152
v_mfma_f32_4x4x4_16b_bf16 v[104:107], v[196:197], v[196:197], v[104:107]
v_mfma_f32_4x4x4_16b_bf16 v[108:111], v[198:199], v[198:199], v[108:111]
s_waitcnt lgkmcnt(0)
v_mfma_f32_32x32x16_bf16 v[16:31], v[64:67], v[200:203], v[16:31]
v_mfma_f32_32x32x16_bf16 v[32:47], v[68:71], v[200:203], v[32:47]
s_barrier
v_add_u32 v4, 0xffff0000, v4
v_add_u32 v5, 0xffff0000, v5
v_add_u32 v6, 0xffff0000, v6
v_add_u32 v7, 0xffff0000, v7
ds_read_b64_tr_b16 v[88:89], v8 offset:0
ds_read_b64_tr_b16 v[90:91], v8 offset:256
ds_read_b64_tr_b16 v[92:93], v8 offset:1024
ds_read_b64_tr_b16 v[94:95], v8 offset:1280
v_mfma_f32_32x32x16_bf16 v[48:63], v[72:75], v[200:203], v[48:63]
ds_read_b64_tr_b16 v[96:97], v8 offset:2048
ds_read_b64_tr_b16 v[98:99], v8 offset:2304
ds_read_b128 v[208:211], v4 offset:0
v_mfma_f32_4x4x4_16b_bf16 v[104:107], v[200:201], v[200:201], v[104:107]
v_mfma_f32_4x4x4_16b_bf16 v[108:111], v[202:203], v[202:203], v[108:111]
s_waitcnt lgkmcnt(7)
v_mfma_f32_32x32x16_bf16 v[16:31], v[76:79], v[204:207], v[16:31]
ds_read_b64_tr_b16 v[64:65], v8 offset:3072
ds_read_b64_tr_b16 v[66:67], v8 offset:3328
ds_read_b64_tr_b16 v[68:69], v8 offset:4096
v_mfma_f32_32x32x16_bf16 v[32:47], v[80:83], v[204:207], v[32:47]
ds_read_b64_tr_b16 v[70:71], v8 offset:4352
ds_read_b64_tr_b16 v[72:73], v8 offset:5120
v_mfma_f32_32x32x16_bf16 v[48:63], v[84:87], v[204:207], v[48:63]
ds_read_b64_tr_b16 v[74:75], v8 offset:5376
ds_read_b128 v[212:215], v5 offset:0
v_mfma_f32_4x4x4_16b_bf16 v[104:107], v[204:205], v[204:205], v[104:107]
v_mfma_f32_4x4x4_16b_bf16 v[108:111], v[206:207], v[206:207], v[108:111]
s_waitcnt lgkmcnt(7)
v_mfma_f32_32x32x16_bf16 v[16:31], v[88:91], v[208:211], v[16:31]
ds_read_b64_tr_b16 v[76:77], v8 offset:6144
ds_read_b64_tr_b16 v[78:79], v8 offset:6400
ds_read_b64_tr_b16 v[80:81], v8 offset:7168
v_mfma_f32_32x32x16_bf16 v[32:47], v[92:95], v[208:211], v[32:47]
ds_read_b64_tr_b16 v[82:83], v8 offset:7424
ds_read_b64_tr_b16 v[84:85], v8 offset:8192
v_mfma_f32_32x32x16_bf16 v[48:63], v[96:99], v[208:211], v[48:63]
ds_read_b64_tr_b16 v[86:87], v8 offset:8448
ds_read_b128 v[216:219], v6 offset:0
v_mfma_f32_4x4x4_16b_bf16 v[104:107], v[208:209], v[208:209], v[104:107]
v_mfma_f32_4x4x4_16b_bf16 v[108:111], v[210:211], v[210:211], v[108:111]
s_waitcnt lgkmcnt(7)
v_mfma_f32_32x32x16_bf16 v[16:31], v[64:67], v[212:215], v[16:31]
ds_read_b64_tr_b16 v[88:89], v8 offset:9216
ds_read_b64_tr_b16 v[90:91], v8 offset:9472
ds_read_b64_tr_b16 v[92:93], v8 offset:10240
v_mfma_f32_32x32x16_bf16 v[32:47], v[68:71], v[212:215], v[32:47]
ds_read_b64_tr_b16 v[94:95], v8 offset:10496
ds_read_b64_tr_b16 v[96:97], v8 offset:11264
v_mfma_f32_32x32x16_bf16 v[48:63], v[72:75], v[212:215], v[48:63]
ds_read_b64_tr_b16 v[98:99], v8 offset:11520
ds_read_b128 v[220:223], v7 offset:0
v_mfma_f32_4x4x4_16b_bf16 v[104:107], v[212:213], v[212:213], v[104:107]
v_mfma_f32_4x4x4_16b_bf16 v[108:111], v[214:215], v[214:215], v[108:111]
s_waitcnt lgkmcnt(0)
v_mfma_f32_32x32x16_bf16 v[16:31], v[76:79], v[216:219], v[16:31]
v_mfma_f32_32x32x16_bf16 v[32:47], v[80:83], v[216:219], v[32:47]
s_barrier
ds_read_b64_tr_b16 v[64:65], v8 offset:28672
ds_read_b64_tr_b16 v[66:67], v8 offset:28928
ds_read_b64_tr_b16 v[68:69], v8 offset:29696
ds_read_b64_tr_b16 v[70:71], v8 offset:29952
v_mfma_f32_32x32x16_bf16 v[48:63], v[84:87], v[216:219], v[48:63]
ds_read_b64_tr_b16 v[72:73], v8 offset:30720
ds_read_b64_tr_b16 v[74:75], v8 offset:30976
ds_read_b128 v[224:227], v4 offset:28672
v_mfma_f32_4x4x4_16b_bf16 v[104:107], v[216:217], v[216:217], v[104:107]
v_mfma_f32_4x4x4_16b_bf16 v[108:111], v[218:219], v[218:219], v[108:111]
s_waitcnt lgkmcnt(7)
v_mfma_f32_32x32x16_bf16 v[16:31], v[88:91], v[220:223], v[16:31]
ds_read_b64_tr_b16 v[76:77], v8 offset:31744
ds_read_b64_tr_b16 v[78:79], v8 offset:32000
ds_read_b64_tr_b16 v[80:81], v8 offset:32768
v_mfma_f32_32x32x16_bf16 v[32:47], v[92:95], v[220:223], v[32:47]
ds_read_b64_tr_b16 v[82:83], v8 offset:33024
ds_read_b64_tr_b16 v[84:85], v8 offset:33792
v_mfma_f32_32x32x16_bf16 v[48:63], v[96:99], v[220:223], v[48:63]
ds_read_b64_tr_b16 v[86:87], v8 offset:34048
ds_read_b128 v[228:231], v5 offset:28672
v_mfma_f32_4x4x4_16b_bf16 v[104:107], v[220:221], v[220:221], v[104:107]
v_mfma_f32_4x4x4_16b_bf16 v[108:111], v[222:223], v[222:223], v[108:111]
s_waitcnt lgkmcnt(7)
v_mfma_f32_32x32x16_bf16 v[16:31], v[64:67], v[224:227], v[16:31]
ds_read_b64_tr_b16 v[88:89], v8 offset:34816
ds_read_b64_tr_b16 v[90:91], v8 offset:35072
ds_read_b64_tr_b16 v[92:93], v8 offset:35840
v_mfma_f32_32x32x16_bf16 v[32:47], v[68:71], v[224:227], v[32:47]
ds_read_b64_tr_b16 v[94:95], v8 offset:36096
ds_read_b64_tr_b16 v[96:97], v8 offset:36864
v_mfma_f32_32x32x16_bf16 v[48:63], v[72:75], v[224:227], v[48:63]
ds_read_b64_tr_b16 v[98:99], v8 offset:37120
ds_read_b128 v[232:235], v6 offset:28672
v_mfma_f32_4x4x4_16b_bf16 v[104:107], v[224:225], v[224:225], v[104:107]
v_mfma_f32_4x4x4_16b_bf16 v[108:111], v[226:227], v[226:227], v[108:111]
s_waitcnt lgkmcnt(7)
v_mfma_f32_32x32x16_bf16 v[16:31], v[76:79], v[228:231], v[16:31]
ds_read_b64_tr_b16 v[64:65], v8 offset:37888
ds_read_b64_tr_b16 v[66:67], v8 offset:38144
ds_read_b64_tr_b16 v[68:69], v8 offset:38912
v_mfma_f32_32x32x16_bf16 v[32:47], v[80:83], v[228:231], v[32:47]
ds_read_b64_tr_b16 v[70:71], v8 offset:39168
ds_read_b64_tr_b16 v[72:73], v8 offset:39936
v_mfma_f32_32x32x16_bf16 v[48:63], v[84:87], v[228:231], v[48:63]
ds_read_b64_tr_b16 v[74:75], v8 offset:40192
ds_read_b128 v[236:239], v7 offset:28672
v_mfma_f32_4x4x4_16b_bf16 v[104:107], v[228:229], v[228:229], v[104:107]
v_mfma_f32_4x4x4_16b_bf16 v[108:111], v[230:231], v[230:231], v[108:111]
s_cmp_lg_u32 s4, 0
s_cbranch_scc1 L_G_EPRET0
s_call_b64 s[72:73], L_G_EPCHK
L_G_EPRET0:
s_waitcnt lgkmcnt(0)
v_mfma_f32_32x32x16_bf16 v[16:31], v[88:91], v[232:235], v[16:31]
v_mfma_f32_32x32x16_bf16 v[32:47], v[92:95], v[232:235], v[32:47]
s_barrier
ds_read_b64_tr_b16 v[76:77], v9 offset:0
ds_read_b64_tr_b16 v[78:79], v9 offset:256
ds_read_b64_tr_b16 v[80:81], v9 offset:1024
ds_read_b64_tr_b16 v[82:83], v9 offset:1280
v_mfma_f32_32x32x16_bf16 v[48:63], v[96:99], v[232:235], v[48:63]
ds_read_b64_tr_b16 v[84:85], v9 offset:2048
ds_read_b64_tr_b16 v[86:87], v9 offset:2304
ds_read_b128 v[240:243], v4 offset:57344
v_mfma_f32_4x4x4_16b_bf16 v[104:107], v[232:233], v[232:233], v[104:107]
v_mfma_f32_4x4x4_16b_bf16 v[108:111], v[234:235], v[234:235], v[108:111]
s_waitcnt lgkmcnt(7)
v_mfma_f32_32x32x16_bf16 v[16:31], v[64:67], v[236:239], v[16:31]
ds_read_b64_tr_b16 v[88:89], v9 offset:3072
ds_read_b64_tr_b16 v[90:91], v9 offset:3328
ds_read_b64_tr_b16 v[92:93], v9 offset:4096
v_mfma_f32_32x32x16_bf16 v[32:47], v[68:71], v[236:239], v[32:47]
ds_read_b64_tr_b16 v[94:95], v9 offset:4352
ds_read_b64_tr_b16 v[96:97], v9 offset:5120
v_mfma_f32_32x32x16_bf16 v[48:63], v[72:75], v[236:239], v[48:63]
ds_read_b64_tr_b16 v[98:99], v9 offset:5376
ds_read_b128 v[244:247], v5 offset:57344
v_mfma_f32_4x4x4_16b_bf16 v[104:107], v[236:237], v[236:237], v[104:107]
v_mfma_f32_4x4x4_16b_bf16 v[108:111], v[238:239], v[238:239], v[108:111]
s_waitcnt lgkmcnt(7)
v_mfma_f32_32x32x16_bf16 v[16:31], v[76:79], v[240:243], v[16:31]
ds_read_b64_tr_b16 v[64:65], v9 offset:6144
ds_read_b64_tr_b16 v[66:67], v9 offset:6400
ds_read_b64_tr_b16 v[68:69], v9 offset:7168
v_mfma_f32_32x32x16_bf16 v[32:47], v[80:83], v[240:243], v[32:47]
ds_read_b64_tr_b16 v[70:71], v9 offset:7424
ds_read_b64_tr_b16 v[72:73], v9 offset:8192
v_mfma_f32_32x32x16_bf16 v[48:63], v[84:87], v[240:243], v[48:63]
ds_read_b64_tr_b16 v[74:75], v9 offset:8448
ds_read_b128 v[248:251], v6 offset:57344
v_mfma_f32_4x4x4_16b_bf16 v[104:107], v[240:241], v[240:241], v[104:107]
v_mfma_f32_4x4x4_16b_bf16 v[108:111], v[242:243], v[242:243], v[108:111]
s_waitcnt lgkmcnt(7)
v_mfma_f32_32x32x16_bf16 v[16:31], v[88:91], v[244:247], v[16:31]
ds_read_b64_tr_b16 v[76:77], v9 offset:9216
ds_read_b64_tr_b16 v[78:79], v9 offset:9472
ds_read_b64_tr_b16 v[80:81], v9 offset:10240
v_mfma_f32_32x32x16_bf16 v[32:47], v[92:95], v[244:247], v[32:47]
ds_read_b64_tr_b16 v[82:83], v9 offset:10496
ds_read_b64_tr_b16 v[84:85], v9 offset:11264
v_mfma_f32_32x32x16_bf16 v[48:63], v[96:99], v[244:247], v[48:63]
ds_read_b64_tr_b16 v[86:87], v9 offset:11520
ds_read_b128 v[252:255], v7 offset:57344
v_mfma_f32_4x4x4_16b_bf16 v[104:107], v[244:245], v[244:245], v[104:107]
v_mfma_f32_4x4x4_16b_bf16 v[108:111], v[246:247], v[246:247], v[108:111]
s_waitcnt lgkmcnt(0)
v_mfma_f32_32x32x16_bf16 v[16:31], v[64:67], v[248:251], v[16:31]
v_mfma_f32_32x32x16_bf16 v[32:47], v[68:71], v[248:251], v[32:47]
s_barrier
v_mfma_f32_32x32x16_bf16 v[48:63], v[72:75], v[248:251], v[48:63]
v_mfma_f32_4x4x4_16b_bf16 v[104:107], v[248:249], v[248:249], v[104:107]
v_mfma_f32_4x4x4_16b_bf16 v[108:111], v[250:251], v[250:251], v[108:111]
s_waitcnt lgkmcnt(0)
v_mov_b32 v1, 161024
ds_read_b32 v125, v1
v_mfma_f32_32x32x16_bf16 v[16:31], v[76:79], v[252:255], v[16:31]
v_mfma_f32_32x32x16_bf16 v[32:47], v[80:83], v[252:255], v[32:47]
v_mfma_f32_32x32x16_bf16 v[48:63], v[84:87], v[252:255], v[48:63]
v_mfma_f32_4x4x4_16b_bf16 v[104:107], v[252:253], v[252:253], v[104:107]
v_mfma_f32_4x4x4_16b_bf16 v[108:111], v[254:255], v[254:255], v[108:111]
s_branch L_G_P1_END
L_G_P1_1:
ds_read_b64_tr_b16 v[64:65], v8 offset:0
ds_read_b64_tr_b16 v[66:67], v8 offset:256
ds_read_b64_tr_b16 v[68:69], v8 offset:1024
ds_read_b64_tr_b16 v[70:71], v8 offset:1280
ds_read_b64_tr_b16 v[72:73], v8 offset:2048
ds_read_b64_tr_b16 v[74:75], v8 offset:2304
ds_read_b128 v[128:131], v4 offset:0
ds_read_b64_tr_b16 v[76:77], v8 offset:3072
ds_read_b64_tr_b16 v[78:79], v8 offset:3328
ds_read_b64_tr_b16 v[80:81], v8 offset:4096
ds_read_b64_tr_b16 v[82:83], v8 offset:4352
ds_read_b64_tr_b16 v[84:85], v8 offset:5120
ds_read_b64_tr_b16 v[86:87], v8 offset:5376
ds_read_b128 v[132:135], v5 offset:0
s_waitcnt lgkmcnt(7)
v_mfma_f32_32x32x16_bf16 v[16:31], v[64:67], v[128:131], 0
ds_read_b64_tr_b16 v[88:89], v8 offset:6144
ds_read_b64_tr_b16 v[90:91], v8 offset:6400
ds_read_b64_tr_b16 v[92:93], v8 offset:7168
v_mfma_f32_32x32x16_bf16 v[32:47], v[68:71], v[128:131], 0
ds_read_b64_tr_b16 v[94:95], v8 offset:7424
ds_read_b64_tr_b16 v[96:97], v8 offset:8192
v_mfma_f32_32x32x16_bf16 v[48:63], v[128:131], v[72:75], 0
ds_read_b64_tr_b16 v[98:99], v8 offset:8448
ds_read_b128 v[136:139], v6 offset:0
v_mfma_f32_4x4x4_16b_bf16 v[104:107], v[128:129], v[128:129], 0
v_mfma_f32_4x4x4_16b_bf16 v[108:111], v[130:131], v[130:131], 0
s_waitcnt lgkmcnt(7)
v_mfma_f32_32x32x16_bf16 v[16:31], v[76:79], v[132:135], v[16:31]
ds_read_b64_tr_b16 v[64:65], v8 offset:9216
ds_read_b64_tr_b16 v[66:67], v8 offset:9472
ds_read_b64_tr_b16 v[68:69], v8 offset:10240
v_mfma_f32_32x32x16_bf16 v[32:47], v[80:83], v[132:135], v[32:47]
ds_read_b64_tr_b16 v[70:71], v8 offset:10496
ds_read_b64_tr_b16 v[72:73], v8 offset:11264
v_mfma_f32_32x32x16_bf16 v[48:63], v[132:135], v[84:87], v[48:63]
ds_read_b64_tr_b16 v[74:75], v8 offset:11520
ds_read_b128 v[140:143], v7 offset:0
v_mfma_f32_4x4x4_16b_bf16 v[104:107], v[132:133], v[132:133], v[104:107]
v_mfma_f32_4x4x4_16b_bf16 v[108:111], v[134:135], v[134:135], v[108:111]
s_waitcnt lgkmcnt(0)
v_mfma_f32_32x32x16_bf16 v[16:31], v[88:91], v[136:139], v[16:31]
v_mfma_f32_32x32x16_bf16 v[32:47], v[92:95], v[136:139], v[32:47]
s_barrier
ds_read_b64_tr_b16 v[76:77], v8 offset:28672
ds_read_b64_tr_b16 v[78:79], v8 offset:28928
ds_read_b64_tr_b16 v[80:81], v8 offset:29696
ds_read_b64_tr_b16 v[82:83], v8 offset:29952
v_mfma_f32_32x32x16_bf16 v[48:63], v[136:139], v[96:99], v[48:63]
ds_read_b64_tr_b16 v[84:85], v8 offset:30720
ds_read_b64_tr_b16 v[86:87], v8 offset:30976
ds_read_b128 v[144:147], v4 offset:28672
v_mfma_f32_4x4x4_16b_bf16 v[104:107], v[136:137], v[136:137], v[104:107]
v_mfma_f32_4x4x4_16b_bf16 v[108:111], v[138:139], v[138:139], v[108:111]
s_waitcnt lgkmcnt(7)
v_mfma_f32_32x32x16_bf16 v[16:31], v[64:67], v[140:143], v[16:31]
ds_read_b64_tr_b16 v[88:89], v8 offset:31744
ds_read_b64_tr_b16 v[90:91], v8 offset:32000
ds_read_b64_tr_b16 v[92:93], v8 offset:32768
v_mfma_f32_32x32x16_bf16 v[32:47], v[68:71], v[140:143], v[32:47]
ds_read_b64_tr_b16 v[94:95], v8 offset:33024
ds_read_b64_tr_b16 v[96:97], v8 offset:33792
v_mfma_f32_32x32x16_bf16 v[48:63], v[140:143], v[72:75], v[48:63]
ds_read_b64_tr_b16 v[98:99], v8 offset:34048
ds_read_b128 v[148:151], v5 offset:28672
v_mfma_f32_4x4x4_16b_bf16 v[104:107], v[140:141], v[140:141], v[104:107]
v_mfma_f32_4x4x4_16b_bf16 v[108:111], v[142:143], v[142:143], v[108:111]
s_waitcnt lgkmcnt(7)
v_mfma_f32_32x32x16_bf16 v[16:31], v[76:79], v[144:147], v[16:31]
ds_read_b64_tr_b16 v[64:65], v8 offset:34816
ds_read_b64_tr_b16 v[66:67], v8 offset:35072
ds_read_b64_tr_b16 v[68:69], v8 offset:35840
v_mfma_f32_32x32x16_bf16 v[32:47], v[80:83], v[144:147], v[32:47]
ds_read_b64_tr_b16 v[70:71], v8 offset:36096
ds_read_b64_tr_b16 v[72:73], v8 offset:36864
v_mfma_f32_32x32x16_bf16 v[48:63], v[144:147], v[84:87], v[48:63]
ds_read_b64_tr_b16 v[74:75], v8 offset:37120
ds_read_b128 v[152:155], v6 offset:28672
v_mfma_f32_4x4x4_16b_bf16 v[104:107], v[144:145], v[144:145], v[104:107]
v_mfma_f32_4x4x4_16b_bf16 v[108:111], v[146:147], v[146:147], v[108:111]
s_waitcnt lgkmcnt(7)
v_mfma_f32_32x32x16_bf16 v[16:31], v[88:91], v[148:151], v[16:31]
ds_read_b64_tr_b16 v[76:77], v8 offset:37888
ds_read_b64_tr_b16 v[78:79], v8 offset:38144
ds_read_b64_tr_b16 v[80:81], v8 offset:38912
v_mfma_f32_32x32x16_bf16 v[32:47], v[92:95], v[148:151], v[32:47]
ds_read_b64_tr_b16 v[82:83], v8 offset:39168
ds_read_b64_tr_b16 v[84:85], v8 offset:39936
v_mfma_f32_32x32x16_bf16 v[48:63], v[148:151], v[96:99], v[48:63]
ds_read_b64_tr_b16 v[86:87], v8 offset:40192
ds_read_b128 v[156:159], v7 offset:28672
v_mfma_f32_4x4x4_16b_bf16 v[104:107], v[148:149], v[148:149], v[104:107]
v_mfma_f32_4x4x4_16b_bf16 v[108:111], v[150:151], v[150:151], v[108:111]
s_waitcnt lgkmcnt(0)
v_mfma_f32_32x32x16_bf16 v[16:31], v[64:67], v[152:155], v[16:31]
v_mfma_f32_32x32x16_bf16 v[32:47], v[68:71], v[152:155], v[32:47]
s_barrier
ds_read_b64_tr_b16 v[88:89], v9 offset:0
ds_read_b64_tr_b16 v[90:91], v9 offset:256
ds_read_b64_tr_b16 v[92:93], v9 offset:1024
ds_read_b64_tr_b16 v[94:95], v9 offset:1280
v_mfma_f32_32x32x16_bf16 v[48:63], v[152:155], v[72:75], v[48:63]
ds_read_b64_tr_b16 v[96:97], v9 offset:2048
ds_read_b64_tr_b16 v[98:99], v9 offset:2304
ds_read_b128 v[160:163], v4 offset:57344
v_mfma_f32_4x4x4_16b_bf16 v[104:107], v[152:153], v[152:153], v[104:107]
v_mfma_f32_4x4x4_16b_bf16 v[108:111], v[154:155], v[154:155], v[108:111]
s_waitcnt lgkmcnt(7)
v_mfma_f32_32x32x16_bf16 v[16:31], v[76:79], v[156:159], v[16:31]
ds_read_b64_tr_b16 v[64:65], v9 offset:3072
ds_read_b64_tr_b16 v[66:67], v9 offset:3328
ds_read_b64_tr_b16 v[68:69], v9 offset:4096
v_mfma_f32_32x32x16_bf16 v[32:47], v[80:83], v[156:159], v[32:47]
ds_read_b64_tr_b16 v[70:71], v9 offset:4352
ds_read_b64_tr_b16 v[72:73], v9 offset:5120
v_mfma_f32_32x32x16_bf16 v[48:63], v[156:159], v[84:87], v[48:63]
ds_read_b64_tr_b16 v[74:75], v9 offset:5376
ds_read_b128 v[164:167], v5 offset:57344
v_mfma_f32_4x4x4_16b_bf16 v[104:107], v[156:157], v[156:157], v[104:107]
v_mfma_f32_4x4x4_16b_bf16 v[108:111], v[158:159], v[158:159], v[108:111]
s_waitcnt lgkmcnt(7)
v_mfma_f32_32x32x16_bf16 v[16:31], v[88:91], v[160:163], v[16:31]
ds_read_b64_tr_b16 v[76:77], v9 offset:6144
ds_read_b64_tr_b16 v[78:79], v9 offset:6400
ds_read_b64_tr_b16 v[80:81], v9 offset:7168
v_mfma_f32_32x32x16_bf16 v[32:47], v[92:95], v[160:163], v[32:47]
ds_read_b64_tr_b16 v[82:83], v9 offset:7424
ds_read_b64_tr_b16 v[84:85], v9 offset:8192
v_mfma_f32_32x32x16_bf16 v[48:63], v[160:163], v[96:99], v[48:63]
ds_read_b64_tr_b16 v[86:87], v9 offset:8448
ds_read_b128 v[168:171], v6 offset:57344
v_mfma_f32_4x4x4_16b_bf16 v[104:107], v[160:161], v[160:161], v[104:107]
v_mfma_f32_4x4x4_16b_bf16 v[108:111], v[162:163], v[162:163], v[108:111]
s_waitcnt lgkmcnt(7)
s_cmp_eq_u32 s4, 0
s_cbranch_scc0 L_G_NOEP1
v_mov_b32 v1, 0
buffer_load_dword v125, v1, s[36:39], 0 offen sc1
L_G_NOEP1:
v_mfma_f32_32x32x16_bf16 v[16:31], v[64:67], v[164:167], v[16:31]
ds_read_b64_tr_b16 v[88:89], v9 offset:9216
ds_read_b64_tr_b16 v[90:91], v9 offset:9472
ds_read_b64_tr_b16 v[92:93], v9 offset:10240
v_mfma_f32_32x32x16_bf16 v[32:47], v[68:71], v[164:167], v[32:47]
ds_read_b64_tr_b16 v[94:95], v9 offset:10496
ds_read_b64_tr_b16 v[96:97], v9 offset:11264
v_mfma_f32_32x32x16_bf16 v[48:63], v[164:167], v[72:75], v[48:63]
ds_read_b64_tr_b16 v[98:99], v9 offset:11520
ds_read_b128 v[172:175], v7 offset:57344
v_mfma_f32_4x4x4_16b_bf16 v[104:107], v[164:165], v[164:165], v[104:107]
v_mfma_f32_4x4x4_16b_bf16 v[108:111], v[166:167], v[166:167], v[108:111]
s_waitcnt lgkmcnt(0)
v_mfma_f32_32x32x16_bf16 v[16:31], v[76:79], v[168:171], v[16:31]
v_mfma_f32_32x32x16_bf16 v[32:47], v[80:83], v[168:171], v[32:47]
s_barrier
v_add_u32 v4, 0x10000, v4
v_add_u32 v5, 0x10000, v5
v_add_u32 v6, 0x10000, v6
v_add_u32 v7, 0x10000, v7
ds_read_b64_tr_b16 v[64:65], v9 offset:28672
ds_read_b64_tr_b16 v[66:67], v9 offset:28928
ds_read_b64_tr_b16 v[68:69], v9 offset:29696
ds_read_b64_tr_b16 v[70:71], v9 offset:29952
v_mfma_f32_32x32x16_bf16 v[48:63], v[168:171], v[84:87], v[48:63]
ds_read_b64_tr_b16 v[72:73], v9 offset:30720
ds_read_b64_tr_b16 v[74:75], v9 offset:30976
ds_read_b128 v[176:179], v4 offset:20480
v_mfma_f32_4x4x4_16b_bf16 v[104:107], v[168:169], v[168:169], v[104:107]
v_mfma_f32_4x4x4_16b_bf16 v[108:111], v[170:171], v[170:171], v[108:111]
s_waitcnt lgkmcnt(7)
v_mfma_f32_32x32x16_bf16 v[16:31], v[88:91], v[172:175], v[16:31]
ds_read_b64_tr_b16 v[76:77], v9 offset:31744
ds_read_b64_tr_b16 v[78:79], v9 offset:32000
ds_read_b64_tr_b16 v[80:81], v9 offset:32768
v_mfma_f32_32x32x16_bf16 v[32:47], v[92:95], v[172:175], v[32:47]
ds_read_b64_tr_b16 v[82:83], v9 offset:33024
ds_read_b64_tr_b16 v[84:85], v9 offset:33792
v_mfma_f32_32x32x16_bf16 v[48:63], v[172:175], v[96:99], v[48:63]
ds_read_b64_tr_b16 v[86:87], v9 offset:34048
ds_read_b128 v[180:183], v5 offset:20480
v_mfma_f32_4x4x4_16b_bf16 v[104:107], v[172:173], v[172:173], v[104:107]
v_mfma_f32_4x4x4_16b_bf16 v[108:111], v[174:175], v[174:175], v[108:111]
s_waitcnt lgkmcnt(7)
v_mfma_f32_32x32x16_bf16 v[16:31], v[64:67], v[176:179], v[16:31]
ds_read_b64_tr_b16 v[88:89], v9 offset:34816
ds_read_b64_tr_b16 v[90:91], v9 offset:35072
ds_read_b64_tr_b16 v[92:93], v9 offset:35840
v_mfma_f32_32x32x16_bf16 v[32:47], v[68:71], v[176:179], v[32:47]
ds_read_b64_tr_b16 v[94:95], v9 offset:36096
ds_read_b64_tr_b16 v[96:97], v9 offset:36864
v_mfma_f32_32x32x16_bf16 v[48:63], v[176:179], v[72:75], v[48:63]
ds_read_b64_tr_b16 v[98:99], v9 offset:37120
ds_read_b128 v[184:187], v6 offset:20480
v_mfma_f32_4x4x4_16b_bf16 v[104:107], v[176:177], v[176:177], v[104:107]
v_mfma_f32_4x4x4_16b_bf16 v[108:111], v[178:179], v[178:179], v[108:111]
s_waitcnt lgkmcnt(7)
v_mfma_f32_32x32x16_bf16 v[16:31], v[76:79], v[180:183], v[16:31]
ds_read_b64_tr_b16 v[64:65], v9 offset:37888
ds_read_b64_tr_b16 v[66:67], v9 offset:38144
ds_read_b64_tr_b16 v[68:69], v9 offset:38912
v_mfma_f32_32x32x16_bf16 v[32:47], v[80:83], v[180:183], v[32:47]
ds_read_b64_tr_b16 v[70:71], v9 offset:39168
ds_read_b64_tr_b16 v[72:73], v9 offset:39936
v_mfma_f32_32x32x16_bf16 v[48:63], v[180:183], v[84:87], v[48:63]
ds_read_b64_tr_b16 v[74:75], v9 offset:40192
ds_read_b128 v[188:191], v7 offset:20480
v_mfma_f32_4x4x4_16b_bf16 v[104:107], v[180:181], v[180:181], v[104:107]
v_mfma_f32_4x4x4_16b_bf16 v[108:111], v[182:183], v[182:183], v[108:111]
s_waitcnt lgkmcnt(0)
v_mfma_f32_32x32x16_bf16 v[16:31], v[88:91], v[184:187], v[16:31]
v_mfma_f32_32x32x16_bf16 v[32:47], v[92:95], v[184:187], v[32:47]
s_barrier
ds_read_b64_tr_b16 v[76:77], v10 offset:0
ds_read_b64_tr_b16 v[78:79], v10 offset:256
ds_read_b64_tr_b16 v[80:81], v10 offset:1024
ds_read_b64_tr_b16 v[82:83], v10 offset:1280
v_mfma_f32_32x32x16_bf16 v[48:63], v[184:187], v[96:99], v[48:63]
ds_read_b64_tr_b16 v[84:85], v10 offset:2048
ds_read_b64_tr_b16 v[86:87], v10 offset:2304
ds_read_b128 v[192:195], v4 offset:49152
v_mfma_f32_4x4x4_16b_bf16 v[104:107], v[184:185], v[184:185], v[104:107]
v_mfma_f32_4x4x4_16b_bf16 v[108:111], v[186:187], v[186:187], v[108:111]
s_waitcnt lgkmcnt(7)
v_mfma_f32_32x32x16_bf16 v[16:31], v[64:67], v[188:191], v[16:31]
ds_read_b64_tr_b16 v[88:89], v10 offset:3072
ds_read_b64_tr_b16 v[90:91], v10 offset:3328
ds_read_b64_tr_b16 v[92:93], v10 offset:4096
v_mfma_f32_32x32x16_bf16 v[32:47], v[68:71], v[188:191], v[32:47]
ds_read_b64_tr_b16 v[94:95], v10 offset:4352
ds_read_b64_tr_b16 v[96:97], v10 offset:5120
v_mfma_f32_32x32x16_bf16 v[48:63], v[188:191], v[72:75], v[48:63]
ds_read_b64_tr_b16 v[98:99], v10 offset:5376
ds_read_b128 v[196:199], v5 offset:49152
v_mfma_f32_4x4x4_16b_bf16 v[104:107], v[188:189], v[188:189], v[104:107]
v_mfma_f32_4x4x4_16b_bf16 v[108:111], v[190:191], v[190:191], v[108:111]
s_waitcnt lgkmcnt(7)
v_mfma_f32_32x32x16_bf16 v[16:31], v[76:79], v[192:195], v[16:31]
ds_read_b64_tr_b16 v[64:65], v10 offset:6144
ds_read_b64_tr_b16 v[66:67], v10 offset:6400
ds_read_b64_tr_b16 v[68:69], v10 offset:7168
v_mfma_f32_32x32x16_bf16 v[32:47], v[80:83], v[192:195], v[32:47]
ds_read_b64_tr_b16 v[70:71], v10 offset:7424
ds_read_b64_tr_b16 v[72:73], v10 offset:8192
v_mfma_f32_32x32x16_bf16 v[48:63], v[192:195], v[84:87], v[48:63]
ds_read_b64_tr_b16 v[74:75], v10 offset:8448
ds_read_b128 v[200:203], v6 offset:49152
v_mfma_f32_4x4x4_16b_bf16 v[104:107], v[192:193], v[192:193], v[104:107]
v_mfma_f32_4x4x4_16b_bf16 v[108:111], v[194:195], v[194:195], v[108:111]
s_waitcnt lgkmcnt(7)
v_mfma_f32_32x32x16_bf16 v[16:31], v[88:91], v[196:199], v[16:31]
ds_read_b64_tr_b16 v[76:77], v10 offset:9216
ds_read_b64_tr_b16 v[78:79], v10 offset:9472
ds_read_b64_tr_b16 v[80:81], v10 offset:10240
v_mfma_f32_32x32x16_bf16 v[32:47], v[92:95], v[196:199], v[32:47]
ds_read_b64_tr_b16 v[82:83], v10 offset:10496
ds_read_b64_tr_b16 v[84:85], v10 offset:11264
v_mfma_f32_32x32x16_bf16 v[48:63], v[196:199], v[96:99], v[48:63]
ds_read_b64_tr_b16 v[86:87], v10 offset:11520
ds_read_b128 v[204:207], v7 offset:49152
v_mfma_f32_4x4x4_16b_bf16 v[104:107], v[196:197], v[196:197], v[104:107]
v_mfma_f32_4x4x4_16b_bf16 v[108:111], v[198:199], v[198:199], v[108:111]
s_waitcnt lgkmcnt(0)
v_mfma_f32_32x32x16_bf16 v[16:31], v[64:67], v[200:203], v[16:31]
v_mfma_f32_32x32x16_bf16 v[32:47], v[68:71], v[200:203], v[32:47]
s_barrier
v_add_u32 v4, 0xffff0000, v4
v_add_u32 v5, 0xffff0000, v5
v_add_u32 v6, 0xffff0000, v6
v_add_u32 v7, 0xffff0000, v7
ds_read_b64_tr_b16 v[88:89], v8 offset:0
ds_read_b64_tr_b16 v[90:91], v8 offset:256
ds_read_b64_tr_b16 v[92:93], v8 offset:1024
ds_read_b64_tr_b16 v[94:95], v8 offset:1280
v_mfma_f32_32x32x16_bf16 v[48:63], v[200:203], v[72:75], v[48:63]
ds_read_b64_tr_b16 v[96:97], v8 offset:2048
ds_read_b64_tr_b16 v[98:99], v8 offset:2304
ds_read_b128 v[208:211], v4 offset:0
v_mfma_f32_4x4x4_16b_bf16 v[104:107], v[200:201], v[200:201], v[104:107]
v_mfma_f32_4x4x4_16b_bf16 v[108:111], v[202:203], v[202:203], v[108:111]
s_waitcnt lgkmcnt(7)
v_mfma_f32_32x32x16_bf16 v[16:31], v[76:79], v[204:207], v[16:31]
ds_read_b64_tr_b16 v[64:65], v8 offset:3072
ds_read_b64_tr_b16 v[66:67], v8 offset:3328
ds_read_b64_tr_b16 v[68:69], v8 offset:4096
v_mfma_f32_32x32x16_bf16 v[32:47], v[80:83], v[204:207], v[32:47]
ds_read_b64_tr_b16 v[70:71], v8 offset:4352
ds_read_b64_tr_b16 v[72:73], v8 offset:5120
v_mfma_f32_32x32x16_bf16 v[48:63], v[204:207], v[84:87], v[48:63]
ds_read_b64_tr_b16 v[74:75], v8 offset:5376
ds_read_b128 v[212:215], v5 offset:0
v_mfma_f32_4x4x4_16b_bf16 v[104:107], v[204:205], v[204:205], v[104:107]
v_mfma_f32_4x4x4_16b_bf16 v[108:111], v[206:207], v[206:207], v[108:111]
s_waitcnt lgkmcnt(7)
v_mfma_f32_32x32x16_bf16 v[16:31], v[88:91], v[208:211], v[16:31]
ds_read_b64_tr_b16 v[76:77], v8 offset:6144
ds_read_b64_tr_b16 v[78:79], v8 offset:6400
ds_read_b64_tr_b16 v[80:81], v8 offset:7168
v_mfma_f32_32x32x16_bf16 v[32:47], v[92:95], v[208:211], v[32:47]
ds_read_b64_tr_b16 v[82:83], v8 offset:7424
ds_read_b64_tr_b16 v[84:85], v8 offset:8192
v_mfma_f32_32x32x16_bf16 v[48:63], v[208:211], v[96:99], v[48:63]
ds_read_b64_tr_b16 v[86:87], v8 offset:8448
ds_read_b128 v[216:219], v6 offset:0
v_mfma_f32_4x4x4_16b_bf16 v[104:107], v[208:209], v[208:209], v[104:107]
v_mfma_f32_4x4x4_16b_bf16 v[108:111], v[210:211], v[210:211], v[108:111]
s_waitcnt lgkmcnt(7)
v_mfma_f32_32x32x16_bf16 v[16:31], v[64:67], v[212:215], v[16:31]
ds_read_b64_tr_b16 v[88:89], v8 offset:9216
ds_read_b64_tr_b16 v[90:91], v8 offset:9472
ds_read_b64_tr_b16 v[92:93], v8 offset:10240
v_mfma_f32_32x32x16_bf16 v[32:47], v[68:71], v[212:215], v[32:47]
ds_read_b64_tr_b16 v[94:95], v8 offset:10496
ds_read_b64_tr_b16 v[96:97], v8 offset:11264
v_mfma_f32_32x32x16_bf16 v[48:63], v[212:215], v[72:75], v[48:63]
ds_read_b64_tr_b16 v[98:99], v8 offset:11520
ds_read_b128 v[220:223], v7 offset:0
v_mfma_f32_4x4x4_16b_bf16 v[104:107], v[212:213], v[212:213], v[104:107]
v_mfma_f32_4x4x4_16b_bf16 v[108:111], v[214:215], v[214:215], v[108:111]
s_waitcnt lgkmcnt(0)
v_mfma_f32_32x32x16_bf16 v[16:31], v[76:79], v[216:219], v[16:31]
v_mfma_f32_32x32x16_bf16 v[32:47], v[80:83], v[216:219], v[32:47]
s_barrier
ds_read_b64_tr_b16 v[64:65], v8 offset:28672
ds_read_b64_tr_b16 v[66:67], v8 offset:28928
ds_read_b64_tr_b16 v[68:69], v8 offset:29696
ds_read_b64_tr_b16 v[70:71], v8 offset:29952
v_mfma_f32_32x32x16_bf16 v[48:63], v[216:219], v[84:87], v[48:63]
ds_read_b64_tr_b16 v[72:73], v8 offset:30720
ds_read_b64_tr_b16 v[74:75], v8 offset:30976
ds_read_b128 v[224:227], v4 offset:28672
v_mfma_f32_4x4x4_16b_bf16 v[104:107], v[216:217], v[216:217], v[104:107]
v_mfma_f32_4x4x4_16b_bf16 v[108:111], v[218:219], v[218:219], v[108:111]
s_waitcnt lgkmcnt(7)
v_mfma_f32_32x32x16_bf16 v[16:31], v[88:91], v[220:223], v[16:31]
ds_read_b64_tr_b16 v[76:77], v8 offset:31744
ds_read_b64_tr_b16 v[78:79], v8 offset:32000
ds_read_b64_tr_b16 v[80:81], v8 offset:32768
v_mfma_f32_32x32x16_bf16 v[32:47], v[92:95], v[220:223], v[32:47]
ds_read_b64_tr_b16 v[82:83], v8 offset:33024
ds_read_b64_tr_b16 v[84:85], v8 offset:33792
v_mfma_f32_32x32x16_bf16 v[48:63], v[220:223], v[96:99], v[48:63]
ds_read_b64_tr_b16 v[86:87], v8 offset:34048
ds_read_b128 v[228:231], v5 offset:28672
v_mfma_f32_4x4x4_16b_bf16 v[104:107], v[220:221], v[220:221], v[104:107]
v_mfma_f32_4x4x4_16b_bf16 v[108:111], v[222:223], v[222:223], v[108:111]
s_waitcnt lgkmcnt(7)
v_mfma_f32_32x32x16_bf16 v[16:31], v[64:67], v[224:227], v[16:31]
ds_read_b64_tr_b16 v[88:89], v8 offset:34816
ds_read_b64_tr_b16 v[90:91], v8 offset:35072
ds_read_b64_tr_b16 v[92:93], v8 offset:35840
v_mfma_f32_32x32x16_bf16 v[32:47], v[68:71], v[224:227], v[32:47]
ds_read_b64_tr_b16 v[94:95], v8 offset:36096
ds_read_b64_tr_b16 v[96:97], v8 offset:36864
v_mfma_f32_32x32x16_bf16 v[48:63], v[224:227], v[72:75], v[48:63]
ds_read_b64_tr_b16 v[98:99], v8 offset:37120
ds_read_b128 v[232:235], v6 offset:28672
v_mfma_f32_4x4x4_16b_bf16 v[104:107], v[224:225], v[224:225], v[104:107]
v_mfma_f32_4x4x4_16b_bf16 v[108:111], v[226:227], v[226:227], v[108:111]
s_waitcnt lgkmcnt(7)
v_mfma_f32_32x32x16_bf16 v[16:31], v[76:79], v[228:231], v[16:31]
ds_read_b64_tr_b16 v[64:65], v8 offset:37888
ds_read_b64_tr_b16 v[66:67], v8 offset:38144
ds_read_b64_tr_b16 v[68:69], v8 offset:38912
v_mfma_f32_32x32x16_bf16 v[32:47], v[80:83], v[228:231], v[32:47]
ds_read_b64_tr_b16 v[70:71], v8 offset:39168
ds_read_b64_tr_b16 v[72:73], v8 offset:39936
v_mfma_f32_32x32x16_bf16 v[48:63], v[228:231], v[84:87], v[48:63]
ds_read_b64_tr_b16 v[74:75], v8 offset:40192
ds_read_b128 v[236:239], v7 offset:28672
v_mfma_f32_4x4x4_16b_bf16 v[104:107], v[228:229], v[228:229], v[104:107]
v_mfma_f32_4x4x4_16b_bf16 v[108:111], v[230:231], v[230:231], v[108:111]
s_cmp_lg_u32 s4, 0
s_cbranch_scc1 L_G_EPRET1
s_call_b64 s[72:73], L_G_EPCHK
L_G_EPRET1:
s_waitcnt lgkmcnt(0)
v_mfma_f32_32x32x16_bf16 v[16:31], v[88:91], v[232:235], v[16:31]
v_mfma_f32_32x32x16_bf16 v[32:47], v[92:95], v[232:235], v[32:47]
s_barrier
ds_read_b64_tr_b16 v[76:77], v9 offset:0
ds_read_b64_tr_b16 v[78:79], v9 offset:256
ds_read_b64_tr_b16 v[80:81], v9 offset:1024
ds_read_b64_tr_b16 v[82:83], v9 offset:1280
v_mfma_f32_32x32x16_bf16 v[48:63], v[232:235], v[96:99], v[48:63]
ds_read_b64_tr_b16 v[84:85], v9 offset:2048
ds_read_b64_tr_b16 v[86:87], v9 offset:2304
ds_read_b128 v[240:243], v4 offset:57344
v_mfma_f32_4x4x4_16b_bf16 v[104:107], v[232:233], v[232:233], v[104:107]
v_mfma_f32_4x4x4_16b_bf16 v[108:111], v[234:235], v[234:235], v[108:111]
s_waitcnt lgkmcnt(7)
v_mfma_f32_32x32x16_bf16 v[16:31], v[64:67], v[236:239], v[16:31]
ds_read_b64_tr_b16 v[88:89], v9 offset:3072
ds_read_b64_tr_b16 v[90:91], v9 offset:3328
ds_read_b64_tr_b16 v[92:93], v9 offset:4096
v_mfma_f32_32x32x16_bf16 v[32:47], v[68:71], v[236:239], v[32:47]
ds_read_b64_tr_b16 v[94:95], v9 offset:4352
ds_read_b64_tr_b16 v[96:97], v9 offset:5120
v_mfma_f32_32x32x16_bf16 v[48:63], v[236:239], v[72:75], v[48:63]
ds_read_b64_tr_b16 v[98:99], v9 offset:5376
ds_read_b128 v[244:247], v5 offset:57344
v_mfma_f32_4x4x4_16b_bf16 v[104:107], v[236:237], v[236:237], v[104:107]
v_mfma_f32_4x4x4_16b_bf16 v[108:111], v[238:239], v[238:239], v[108:111]
s_waitcnt lgkmcnt(7)
v_mfma_f32_32x32x16_bf16 v[16:31], v[76:79], v[240:243], v[16:31]
ds_read_b64_tr_b16 v[64:65], v9 offset:6144
ds_read_b64_tr_b16 v[66:67], v9 offset:6400
ds_read_b64_tr_b16 v[68:69], v9 offset:7168
v_mfma_f32_32x32x16_bf16 v[32:47], v[80:83], v[240:243], v[32:47]
ds_read_b64_tr_b16 v[70:71], v9 offset:7424
ds_read_b64_tr_b16 v[72:73], v9 offset:8192
v_mfma_f32_32x32x16_bf16 v[48:63], v[240:243], v[84:87], v[48:63]
ds_read_b64_tr_b16 v[74:75], v9 offset:8448
ds_read_b128 v[248:251], v6 offset:57344
v_mfma_f32_4x4x4_16b_bf16 v[104:107], v[240:241], v[240:241], v[104:107]
v_mfma_f32_4x4x4_16b_bf16 v[108:111], v[242:243], v[242:243], v[108:111]
s_waitcnt lgkmcnt(7)
v_mfma_f32_32x32x16_bf16 v[16:31], v[88:91], v[244:247], v[16:31]
ds_read_b64_tr_b16 v[76:77], v9 offset:9216
ds_read_b64_tr_b16 v[78:79], v9 offset:9472
ds_read_b64_tr_b16 v[80:81], v9 offset:10240
v_mfma_f32_32x32x16_bf16 v[32:47], v[92:95], v[244:247], v[32:47]
ds_read_b64_tr_b16 v[82:83], v9 offset:10496
ds_read_b64_tr_b16 v[84:85], v9 offset:11264
v_mfma_f32_32x32x16_bf16 v[48:63], v[244:247], v[96:99], v[48:63]
ds_read_b64_tr_b16 v[86:87], v9 offset:11520
ds_read_b128 v[252:255], v7 offset:57344
v_mfma_f32_4x4x4_16b_bf16 v[104:107], v[244:245], v[244:245], v[104:107]
v_mfma_f32_4x4x4_16b_bf16 v[108:111], v[246:247], v[246:247], v[108:111]
s_waitcnt lgkmcnt(0)
v_mfma_f32_32x32x16_bf16 v[16:31], v[64:67], v[248:251], v[16:31]
v_mfma_f32_32x32x16_bf16 v[32:47], v[68:71], v[248:251], v[32:47]
s_barrier
v_mfma_f32_32x32x16_bf16 v[48:63], v[248:251], v[72:75], v[48:63]
v_mfma_f32_4x4x4_16b_bf16 v[104:107], v[248:249], v[248:249], v[104:107]
v_mfma_f32_4x4x4_16b_bf16 v[108:111], v[250:251], v[250:251], v[108:111]
s_waitcnt lgkmcnt(0)
v_mov_b32 v1, 161024
ds_read_b32 v125, v1
v_mfma_f32_32x32x16_bf16 v[16:31], v[76:79], v[252:255], v[16:31]
v_mfma_f32_32x32x16_bf16 v[32:47], v[80:83], v[252:255], v[32:47]
v_mfma_f32_32x32x16_bf16 v[48:63], v[252:255], v[84:87], v[48:63]
v_mfma_f32_4x4x4_16b_bf16 v[104:107], v[252:253], v[252:253], v[104:107]
v_mfma_f32_4x4x4_16b_bf16 v[108:111], v[254:255], v[254:255], v[108:111]
s_branch L_G_P1_END
L_G_P1_2:
ds_read_b64_tr_b16 v[64:65], v8 offset:0
ds_read_b64_tr_b16 v[66:67], v8 offset:256
ds_read_b64_tr_b16 v[68:69], v8 offset:1024
ds_read_b64_tr_b16 v[70:71], v8 offset:1280
ds_read_b64_tr_b16 v[72:73], v8 offset:2048
ds_read_b64_tr_b16 v[74:75], v8 offset:2304
ds_read_b128 v[128:131], v4 offset:0
ds_read_b64_tr_b16 v[76:77], v8 offset:3072
ds_read_b64_tr_b16 v[78:79], v8 offset:3328
ds_read_b64_tr_b16 v[80:81], v8 offset:4096
ds_read_b64_tr_b16 v[82:83], v8 offset:4352
ds_read_b64_tr_b16 v[84:85], v8 offset:5120
ds_read_b64_tr_b16 v[86:87], v8 offset:5376
ds_read_b128 v[132:135], v5 offset:0
s_waitcnt lgkmcnt(7)
v_mfma_f32_32x32x16_bf16 v[16:31], v[128:131], v[64:67], 0
ds_read_b64_tr_b16 v[88:89], v8 offset:6144
ds_read_b64_tr_b16 v[90:91], v8 offset:6400
ds_read_b64_tr_b16 v[92:93], v8 offset:7168
v_mfma_f32_32x32x16_bf16 v[32:47], v[128:131], v[68:71], 0
ds_read_b64_tr_b16 v[94:95], v8 offset:7424
ds_read_b64_tr_b16 v[96:97], v8 offset:8192
v_mfma_f32_32x32x16_bf16 v[48:63], v[128:131], v[72:75], 0
ds_read_b64_tr_b16 v[98:99], v8 offset:8448
ds_read_b128 v[136:139], v6 offset:0
v_mfma_f32_4x4x4_16b_bf16 v[104:107], v[128:129], v[128:129], 0
v_mfma_f32_4x4x4_16b_bf16 v[108:111], v[130:131], v[130:131], 0
s_waitcnt lgkmcnt(7)
v_mfma_f32_32x32x16_bf16 v[16:31], v[132:135], v[76:79], v[16:31]
ds_read_b64_tr_b16 v[64:65], v8 offset:9216
ds_read_b64_tr_b16 v[66:67], v8 offset:9472
ds_read_b64_tr_b16 v[68:69], v8 offset:10240
v_mfma_f32_32x32x16_bf16 v[32:47], v[132:135], v[80:83], v[32:47]
ds_read_b64_tr_b16 v[70:71], v8 offset:10496
ds_read_b64_tr_b16 v[72:73], v8 offset:11264
v_mfma_f32_32x32x16_bf16 v[48:63], v[132:135], v[84:87], v[48:63]
ds_read_b64_tr_b16 v[74:75], v8 offset:11520
ds_read_b128 v[140:143], v7 offset:0
v_mfma_f32_4x4x4_16b_bf16 v[104:107], v[132:133], v[132:133], v[104:107]
v_mfma_f32_4x4x4_16b_bf16 v[108:111], v[134:135], v[134:135], v[108:111]
s_waitcnt lgkmcnt(0)
v_mfma_f32_32x32x16_bf16 v[16:31], v[136:139], v[88:91], v[16:31]
v_mfma_f32_32x32x16_bf16 v[32:47], v[136:139], v[92:95], v[32:47]
s_barrier
ds_read_b64_tr_b16 v[76:77], v8 offset:28672
ds_read_b64_tr_b16 v[78:79], v8 offset:28928
ds_read_b64_tr_b16 v[80:81], v8 offset:29696
ds_read_b64_tr_b16 v[82:83], v8 offset:29952
v_mfma_f32_32x32x16_bf16 v[48:63], v[136:139], v[96:99], v[48:63]
ds_read_b64_tr_b16 v[84:85], v8 offset:30720
ds_read_b64_tr_b16 v[86:87], v8 offset:30976
ds_read_b128 v[144:147], v4 offset:28672
v_mfma_f32_4x4x4_16b_bf16 v[104:107], v[136:137], v[136:137], v[104:107]
v_mfma_f32_4x4x4_16b_bf16 v[108:111], v[138:139], v[138:139], v[108:111]
s_waitcnt lgkmcnt(7)
v_mfma_f32_32x32x16_bf16 v[16:31], v[140:143], v[64:67], v[16:31]
ds_read_b64_tr_b16 v[88:89], v8 offset:31744
ds_read_b64_tr_b16 v[90:91], v8 offset:32000
ds_read_b64_tr_b16 v[92:93], v8 offset:32768
v_mfma_f32_32x32x16_bf16 v[32:47], v[140:143], v[68:71], v[32:47]
ds_read_b64_tr_b16 v[94:95], v8 offset:33024
ds_read_b64_tr_b16 v[96:97], v8 offset:33792
v_mfma_f32_32x32x16_bf16 v[48:63], v[140:143], v[72:75], v[48:63]
ds_read_b64_tr_b16 v[98:99], v8 offset:34048
ds_read_b128 v[148:151], v5 offset:28672
v_mfma_f32_4x4x4_16b_bf16 v[104:107], v[140:141], v[140:141], v[104:107]
v_mfma_f32_4x4x4_16b_bf16 v[108:111], v[142:143], v[142:143], v[108:111]
s_waitcnt lgkmcnt(7)
v_mfma_f32_32x32x16_bf16 v[16:31], v[144:147], v[76:79], v[16:31]
ds_read_b64_tr_b16 v[64:65], v8 offset:34816
ds_read_b64_tr_b16 v[66:67], v8 offset:35072
ds_read_b64_tr_b16 v[68:69], v8 offset:35840
v_mfma_f32_32x32x16_bf16 v[32:47], v[144:147], v[80:83], v[32:47]
ds_read_b64_tr_b16 v[70:71], v8 offset:36096
ds_read_b64_tr_b16 v[72:73], v8 offset:36864
v_mfma_f32_32x32x16_bf16 v[48:63], v[144:147], v[84:87], v[48:63]
ds_read_b64_tr_b16 v[74:75], v8 offset:37120
ds_read_b128 v[152:155], v6 offset:28672
v_mfma_f32_4x4x4_16b_bf16 v[104:107], v[144:145], v[144:145], v[104:107]
v_mfma_f32_4x4x4_16b_bf16 v[108:111], v[146:147], v[146:147], v[108:111]
s_waitcnt lgkmcnt(7)
v_mfma_f32_32x32x16_bf16 v[16:31], v[148:151], v[88:91], v[16:31]
ds_read_b64_tr_b16 v[76:77], v8 offset:37888
ds_read_b64_tr_b16 v[78:79], v8 offset:38144
ds_read_b64_tr_b16 v[80:81], v8 offset:38912
v_mfma_f32_32x32x16_bf16 v[32:47], v[148:151], v[92:95], v[32:47]
ds_read_b64_tr_b16 v[82:83], v8 offset:39168
ds_read_b64_tr_b16 v[84:85], v8 offset:39936
v_mfma_f32_32x32x16_bf16 v[48:63], v[148:151], v[96:99], v[48:63]
ds_read_b64_tr_b16 v[86:87], v8 offset:40192
ds_read_b128 v[156:159], v7 offset:28672
v_mfma_f32_4x4x4_16b_bf16 v[104:107], v[148:149], v[148:149], v[104:107]
v_mfma_f32_4x4x4_16b_bf16 v[108:111], v[150:151], v[150:151], v[108:111]
s_waitcnt lgkmcnt(0)
v_mfma_f32_32x32x16_bf16 v[16:31], v[152:155], v[64:67], v[16:31]
v_mfma_f32_32x32x16_bf16 v[32:47], v[152:155], v[68:71], v[32:47]
s_barrier
ds_read_b64_tr_b16 v[88:89], v9 offset:0
ds_read_b64_tr_b16 v[90:91], v9 offset:256
ds_read_b64_tr_b16 v[92:93], v9 offset:1024
ds_read_b64_tr_b16 v[94:95], v9 offset:1280
v_mfma_f32_32x32x16_bf16 v[48:63], v[152:155], v[72:75], v[48:63]
ds_read_b64_tr_b16 v[96:97], v9 offset:2048
ds_read_b64_tr_b16 v[98:99], v9 offset:2304
ds_read_b128 v[160:163], v4 offset:57344
v_mfma_f32_4x4x4_16b_bf16 v[104:107], v[152:153], v[152:153], v[104:107]
v_mfma_f32_4x4x4_16b_bf16 v[108:111], v[154:155], v[154:155], v[108:111]
s_waitcnt lgkmcnt(7)
v_mfma_f32_32x32x16_bf16 v[16:31], v[156:159], v[76:79], v[16:31]
ds_read_b64_tr_b16 v[64:65], v9 offset:3072
ds_read_b64_tr_b16 v[66:67], v9 offset:3328
ds_read_b64_tr_b16 v[68:69], v9 offset:4096
v_mfma_f32_32x32x16_bf16 v[32:47], v[156:159], v[80:83], v[32:47]
ds_read_b64_tr_b16 v[70:71], v9 offset:4352
ds_read_b64_tr_b16 v[72:73], v9 offset:5120
v_mfma_f32_32x32x16_bf16 v[48:63], v[156:159], v[84:87], v[48:63]
ds_read_b64_tr_b16 v[74:75], v9 offset:5376
ds_read_b128 v[164:167], v5 offset:57344
v_mfma_f32_4x4x4_16b_bf16 v[104:107], v[156:157], v[156:157], v[104:107]
v_mfma_f32_4x4x4_16b_bf16 v[108:111], v[158:159], v[158:159], v[108:111]
s_waitcnt lgkmcnt(7)
v_mfma_f32_32x32x16_bf16 v[16:31], v[160:163], v[88:91], v[16:31]
ds_read_b64_tr_b16 v[76:77], v9 offset:6144
ds_read_b64_tr_b16 v[78:79], v9 offset:6400
ds_read_b64_tr_b16 v[80:81], v9 offset:7168
v_mfma_f32_32x32x16_bf16 v[32:47], v[160:163], v[92:95], v[32:47]
ds_read_b64_tr_b16 v[82:83], v9 offset:7424
ds_read_b64_tr_b16 v[84:85], v9 offset:8192
v_mfma_f32_32x32x16_bf16 v[48:63], v[160:163], v[96:99], v[48:63]
ds_read_b64_tr_b16 v[86:87], v9 offset:8448
ds_read_b128 v[168:171], v6 offset:57344
v_mfma_f32_4x4x4_16b_bf16 v[104:107], v[160:161], v[160:161], v[104:107]
v_mfma_f32_4x4x4_16b_bf16 v[108:111], v[162:163], v[162:163], v[108:111]
s_waitcnt lgkmcnt(7)
s_cmp_eq_u32 s4, 0
s_cbranch_scc0 L_G_NOEP2
v_mov_b32 v1, 0
buffer_load_dword v125, v1, s[36:39], 0 offen sc1
L_G_NOEP2:
v_mfma_f32_32x32x16_bf16 v[16:31], v[164:167], v[64:67], v[16:31]
ds_read_b64_tr_b16 v[88:89], v9 offset:9216
ds_read_b64_tr_b16 v[90:91], v9 offset:9472
ds_read_b64_tr_b16 v[92:93], v9 offset:10240
v_mfma_f32_32x32x16_bf16 v[32:47], v[164:167], v[68:71], v[32:47]
ds_read_b64_tr_b16 v[94:95], v9 offset:10496
ds_read_b64_tr_b16 v[96:97], v9 offset:11264
v_mfma_f32_32x32x16_bf16 v[48:63], v[164:167], v[72:75], v[48:63]
ds_read_b64_tr_b16 v[98:99], v9 offset:11520
ds_read_b128 v[172:175], v7 offset:57344
v_mfma_f32_4x4x4_16b_bf16 v[104:107], v[164:165], v[164:165], v[104:107]
v_mfma_f32_4x4x4_16b_bf16 v[108:111], v[166:167], v[166:167], v[108:111]
s_waitcnt lgkmcnt(0)
v_mfma_f32_32x32x16_bf16 v[16:31], v[168:171], v[76:79], v[16:31]
v_mfma_f32_32x32x16_bf16 v[32:47], v[168:171], v[80:83], v[32:47]
s_barrier
v_add_u32 v4, 0x10000, v4
v_add_u32 v5, 0x10000, v5
v_add_u32 v6, 0x10000, v6
v_add_u32 v7, 0x10000, v7
ds_read_b64_tr_b16 v[64:65], v9 offset:28672
ds_read_b64_tr_b16 v[66:67], v9 offset:28928
ds_read_b64_tr_b16 v[68:69], v9 offset:29696
ds_read_b64_tr_b16 v[70:71], v9 offset:29952
v_mfma_f32_32x32x16_bf16 v[48:63], v[168:171], v[84:87], v[48:63]
ds_read_b64_tr_b16 v[72:73], v9 offset:30720
ds_read_b64_tr_b16 v[74:75], v9 offset:30976
ds_read_b128 v[176:179], v4 offset:20480
v_mfma_f32_4x4x4_16b_bf16 v[104:107], v[168:169], v[168:169], v[104:107]
v_mfma_f32_4x4x4_16b_bf16 v[108:111], v[170:171], v[170:171], v[108:111]
s_waitcnt lgkmcnt(7)
v_mfma_f32_32x32x16_bf16 v[16:31], v[172:175], v[88:91], v[16:31]
ds_read_b64_tr_b16 v[76:77], v9 offset:31744
ds_read_b64_tr_b16 v[78:79], v9 offset:32000
ds_read_b64_tr_b16 v[80:81], v9 offset:32768
v_mfma_f32_32x32x16_bf16 v[32:47], v[172:175], v[92:95], v[32:47]
ds_read_b64_tr_b16 v[82:83], v9 offset:33024
ds_read_b64_tr_b16 v[84:85], v9 offset:33792
v_mfma_f32_32x32x16_bf16 v[48:63], v[172:175], v[96:99], v[48:63]
ds_read_b64_tr_b16 v[86:87], v9 offset:34048
ds_read_b128 v[180:183], v5 offset:20480
v_mfma_f32_4x4x4_16b_bf16 v[104:107], v[172:173], v[172:173], v[104:107]
v_mfma_f32_4x4x4_16b_bf16 v[108:111], v[174:175], v[174:175], v[108:111]
s_waitcnt lgkmcnt(7)
v_mfma_f32_32x32x16_bf16 v[16:31], v[176:179], v[64:67], v[16:31]
ds_read_b64_tr_b16 v[88:89], v9 offset:34816
ds_read_b64_tr_b16 v[90:91], v9 offset:35072
ds_read_b64_tr_b16 v[92:93], v9 offset:35840
v_mfma_f32_32x32x16_bf16 v[32:47], v[176:179], v[68:71], v[32:47]
ds_read_b64_tr_b16 v[94:95], v9 offset:36096
ds_read_b64_tr_b16 v[96:97], v9 offset:36864
v_mfma_f32_32x32x16_bf16 v[48:63], v[176:179], v[72:75], v[48:63]
ds_read_b64_tr_b16 v[98:99], v9 offset:37120
ds_read_b128 v[184:187], v6 offset:20480
v_mfma_f32_4x4x4_16b_bf16 v[104:107], v[176:177], v[176:177], v[104:107]
v_mfma_f32_4x4x4_16b_bf16 v[108:111], v[178:179], v[178:179], v[108:111]
s_waitcnt lgkmcnt(7)
v_mfma_f32_32x32x16_bf16 v[16:31], v[180:183], v[76:79], v[16:31]
ds_read_b64_tr_b16 v[64:65], v9 offset:37888
ds_read_b64_tr_b16 v[66:67], v9 offset:38144
ds_read_b64_tr_b16 v[68:69], v9 offset:38912
v_mfma_f32_32x32x16_bf16 v[32:47], v[180:183], v[80:83], v[32:47]
ds_read_b64_tr_b16 v[70:71], v9 offset:39168
ds_read_b64_tr_b16 v[72:73], v9 offset:39936
v_mfma_f32_32x32x16_bf16 v[48:63], v[180:183], v[84:87], v[48:63]
ds_read_b64_tr_b16 v[74:75], v9 offset:40192
ds_read_b128 v[188:191], v7 offset:20480
v_mfma_f32_4x4x4_16b_bf16 v[104:107], v[180:181], v[180:181], v[104:107]
v_mfma_f32_4x4x4_16b_bf16 v[108:111], v[182:183], v[182:183], v[108:111]
s_waitcnt lgkmcnt(0)
v_mfma_f32_32x32x16_bf16 v[16:31], v[184:187], v[88:91], v[16:31]
v_mfma_f32_32x32x16_bf16 v[32:47], v[184:187], v[92:95], v[32:47]
s_barrier
ds_read_b64_tr_b16 v[76:77], v10 offset:0
ds_read_b64_tr_b16 v[78:79], v10 offset:256
ds_read_b64_tr_b16 v[80:81], v10 offset:1024
ds_read_b64_tr_b16 v[82:83], v10 offset:1280
v_mfma_f32_32x32x16_bf16 v[48:63], v[184:187], v[96:99], v[48:63]
ds_read_b64_tr_b16 v[84:85], v10 offset:2048
ds_read_b64_tr_b16 v[86:87], v10 offset:2304
ds_read_b128 v[192:195], v4 offset:49152
v_mfma_f32_4x4x4_16b_bf16 v[104:107], v[184:185], v[184:185], v[104:107]
v_mfma_f32_4x4x4_16b_bf16 v[108:111], v[186:187], v[186:187], v[108:111]
s_waitcnt lgkmcnt(7)
v_mfma_f32_32x32x16_bf16 v[16:31], v[188:191], v[64:67], v[16:31]
ds_read_b64_tr_b16 v[88:89], v10 offset:3072
ds_read_b64_tr_b16 v[90:91], v10 offset:3328
ds_read_b64_tr_b16 v[92:93], v10 offset:4096
v_mfma_f32_32x32x16_bf16 v[32:47], v[188:191], v[68:71], v[32:47]
ds_read_b64_tr_b16 v[94:95], v10 offset:4352
ds_read_b64_tr_b16 v[96:97], v10 offset:5120
v_mfma_f32_32x32x16_bf16 v[48:63], v[188:191], v[72:75], v[48:63]
ds_read_b64_tr_b16 v[98:99], v10 offset:5376
ds_read_b128 v[196:199], v5 offset:49152
v_mfma_f32_4x4x4_16b_bf16 v[104:107], v[188:189], v[188:189], v[104:107]
v_mfma_f32_4x4x4_16b_bf16 v[108:111], v[190:191], v[190:191], v[108:111]
s_waitcnt lgkmcnt(7)
v_mfma_f32_32x32x16_bf16 v[16:31], v[192:195], v[76:79], v[16:31]
ds_read_b64_tr_b16 v[64:65], v10 offset:6144
ds_read_b64_tr_b16 v[66:67], v10 offset:6400
ds_read_b64_tr_b16 v[68:69], v10 offset:7168
v_mfma_f32_32x32x16_bf16 v[32:47], v[192:195], v[80:83], v[32:47]
ds_read_b64_tr_b16 v[70:71], v10 offset:7424
ds_read_b64_tr_b16 v[72:73], v10 offset:8192
v_mfma_f32_32x32x16_bf16 v[48:63], v[192:195], v[84:87], v[48:63]
ds_read_b64_tr_b16 v[74:75], v10 offset:8448
ds_read_b128 v[200:203], v6 offset:49152
v_mfma_f32_4x4x4_16b_bf16 v[104:107], v[192:193], v[192:193], v[104:107]
v_mfma_f32_4x4x4_16b_bf16 v[108:111], v[194:195], v[194:195], v[108:111]
s_waitcnt lgkmcnt(7)
v_mfma_f32_32x32x16_bf16 v[16:31], v[196:199], v[88:91], v[16:31]
ds_read_b64_tr_b16 v[76:77], v10 offset:9216
ds_read_b64_tr_b16 v[78:79], v10 offset:9472
ds_read_b64_tr_b16 v[80:81], v10 offset:10240
v_mfma_f32_32x32x16_bf16 v[32:47], v[196:199], v[92:95], v[32:47]
ds_read_b64_tr_b16 v[82:83], v10 offset:10496
ds_read_b64_tr_b16 v[84:85], v10 offset:11264
v_mfma_f32_32x32x16_bf16 v[48:63], v[196:199], v[96:99], v[48:63]
ds_read_b64_tr_b16 v[86:87], v10 offset:11520
ds_read_b128 v[204:207], v7 offset:49152
v_mfma_f32_4x4x4_16b_bf16 v[104:107], v[196:197], v[196:197], v[104:107]
v_mfma_f32_4x4x4_16b_bf16 v[108:111], v[198:199], v[198:199], v[108:111]
s_waitcnt lgkmcnt(0)
v_mfma_f32_32x32x16_bf16 v[16:31], v[200:203], v[64:67], v[16:31]
v_mfma_f32_32x32x16_bf16 v[32:47], v[200:203], v[68:71], v[32:47]
s_barrier
v_add_u32 v4, 0xffff0000, v4
v_add_u32 v5, 0xffff0000, v5
v_add_u32 v6, 0xffff0000, v6
v_add_u32 v7, 0xffff0000, v7
ds_read_b64_tr_b16 v[88:89], v8 offset:0
ds_read_b64_tr_b16 v[90:91], v8 offset:256
ds_read_b64_tr_b16 v[92:93], v8 offset:1024
ds_read_b64_tr_b16 v[94:95], v8 offset:1280
v_mfma_f32_32x32x16_bf16 v[48:63], v[200:203], v[72:75], v[48:63]
ds_read_b64_tr_b16 v[96:97], v8 offset:2048
ds_read_b64_tr_b16 v[98:99], v8 offset:2304
ds_read_b128 v[208:211], v4 offset:0
v_mfma_f32_4x4x4_16b_bf16 v[104:107], v[200:201], v[200:201], v[104:107]
v_mfma_f32_4x4x4_16b_bf16 v[108:111], v[202:203], v[202:203], v[108:111]
s_waitcnt lgkmcnt(7)
v_mfma_f32_32x32x16_bf16 v[16:31], v[204:207], v[76:79], v[16:31]
ds_read_b64_tr_b16 v[64:65], v8 offset:3072
ds_read_b64_tr_b16 v[66:67], v8 offset:3328
ds_read_b64_tr_b16 v[68:69], v8 offset:4096
v_mfma_f32_32x32x16_bf16 v[32:47], v[204:207], v[80:83], v[32:47]
ds_read_b64_tr_b16 v[70:71], v8 offset:4352
ds_read_b64_tr_b16 v[72:73], v8 offset:5120
v_mfma_f32_32x32x16_bf16 v[48:63], v[204:207], v[84:87], v[48:63]
ds_read_b64_tr_b16 v[74:75], v8 offset:5376
ds_read_b128 v[212:215], v5 offset:0
v_mfma_f32_4x4x4_16b_bf16 v[104:107], v[204:205], v[204:205], v[104:107]
v_mfma_f32_4x4x4_16b_bf16 v[108:111], v[206:207], v[206:207], v[108:111]
s_waitcnt lgkmcnt(7)
v_mfma_f32_32x32x16_bf16 v[16:31], v[208:211], v[88:91], v[16:31]
ds_read_b64_tr_b16 v[76:77], v8 offset:6144
ds_read_b64_tr_b16 v[78:79], v8 offset:6400
ds_read_b64_tr_b16 v[80:81], v8 offset:7168
v_mfma_f32_32x32x16_bf16 v[32:47], v[208:211], v[92:95], v[32:47]
ds_read_b64_tr_b16 v[82:83], v8 offset:7424
ds_read_b64_tr_b16 v[84:85], v8 offset:8192
v_mfma_f32_32x32x16_bf16 v[48:63], v[208:211], v[96:99], v[48:63]
ds_read_b64_tr_b16 v[86:87], v8 offset:8448
ds_read_b128 v[216:219], v6 offset:0
v_mfma_f32_4x4x4_16b_bf16 v[104:107], v[208:209], v[208:209], v[104:107]
v_mfma_f32_4x4x4_16b_bf16 v[108:111], v[210:211], v[210:211], v[108:111]
s_waitcnt lgkmcnt(7)
v_mfma_f32_32x32x16_bf16 v[16:31], v[212:215], v[64:67], v[16:31]
ds_read_b64_tr_b16 v[88:89], v8 offset:9216
ds_read_b64_tr_b16 v[90:91], v8 offset:9472
ds_read_b64_tr_b16 v[92:93], v8 offset:10240
v_mfma_f32_32x32x16_bf16 v[32:47], v[212:215], v[68:71], v[32:47]
ds_read_b64_tr_b16 v[94:95], v8 offset:10496
ds_read_b64_tr_b16 v[96:97], v8 offset:11264
v_mfma_f32_32x32x16_bf16 v[48:63], v[212:215], v[72:75], v[48:63]
ds_read_b64_tr_b16 v[98:99], v8 offset:11520
ds_read_b128 v[220:223], v7 offset:0
v_mfma_f32_4x4x4_16b_bf16 v[104:107], v[212:213], v[212:213], v[104:107]
v_mfma_f32_4x4x4_16b_bf16 v[108:111], v[214:215], v[214:215], v[108:111]
s_waitcnt lgkmcnt(0)
v_mfma_f32_32x32x16_bf16 v[16:31], v[216:219], v[76:79], v[16:31]
v_mfma_f32_32x32x16_bf16 v[32:47], v[216:219], v[80:83], v[32:47]
s_barrier
ds_read_b64_tr_b16 v[64:65], v8 offset:28672
ds_read_b64_tr_b16 v[66:67], v8 offset:28928
ds_read_b64_tr_b16 v[68:69], v8 offset:29696
ds_read_b64_tr_b16 v[70:71], v8 offset:29952
v_mfma_f32_32x32x16_bf16 v[48:63], v[216:219], v[84:87], v[48:63]
ds_read_b64_tr_b16 v[72:73], v8 offset:30720
ds_read_b64_tr_b16 v[74:75], v8 offset:30976
ds_read_b128 v[224:227], v4 offset:28672
v_mfma_f32_4x4x4_16b_bf16 v[104:107], v[216:217], v[216:217], v[104:107]
v_mfma_f32_4x4x4_16b_bf16 v[108:111], v[218:219], v[218:219], v[108:111]
s_waitcnt lgkmcnt(7)
v_mfma_f32_32x32x16_bf16 v[16:31], v[220:223], v[88:91], v[16:31]
ds_read_b64_tr_b16 v[76:77], v8 offset:31744
ds_read_b64_tr_b16 v[78:79], v8 offset:32000
ds_read_b64_tr_b16 v[80:81], v8 offset:32768
v_mfma_f32_32x32x16_bf16 v[32:47], v[220:223], v[92:95], v[32:47]
ds_read_b64_tr_b16 v[82:83], v8 offset:33024
ds_read_b64_tr_b16 v[84:85], v8 offset:33792
v_mfma_f32_32x32x16_bf16 v[48:63], v[220:223], v[96:99], v[48:63]
ds_read_b64_tr_b16 v[86:87], v8 offset:34048
ds_read_b128 v[228:231], v5 offset:28672
v_mfma_f32_4x4x4_16b_bf16 v[104:107], v[220:221], v[220:221], v[104:107]
v_mfma_f32_4x4x4_16b_bf16 v[108:111], v[222:223], v[222:223], v[108:111]
s_waitcnt lgkmcnt(7)
v_mfma_f32_32x32x16_bf16 v[16:31], v[224:227], v[64:67], v[16:31]
ds_read_b64_tr_b16 v[88:89], v8 offset:34816
ds_read_b64_tr_b16 v[90:91], v8 offset:35072
ds_read_b64_tr_b16 v[92:93], v8 offset:35840
v_mfma_f32_32x32x16_bf16 v[32:47], v[224:227], v[68:71], v[32:47]
ds_read_b64_tr_b16 v[94:95], v8 offset:36096
ds_read_b64_tr_b16 v[96:97], v8 offset:36864
v_mfma_f32_32x32x16_bf16 v[48:63], v[224:227], v[72:75], v[48:63]
ds_read_b64_tr_b16 v[98:99], v8 offset:37120
ds_read_b128 v[232:235], v6 offset:28672
v_mfma_f32_4x4x4_16b_bf16 v[104:107], v[224:225], v[224:225], v[104:107]
v_mfma_f32_4x4x4_16b_bf16 v[108:111], v[226:227], v[226:227], v[108:111]
s_waitcnt lgkmcnt(7)
v_mfma_f32_32x32x16_bf16 v[16:31], v[228:231], v[76:79], v[16:31]
ds_read_b64_tr_b16 v[64:65], v8 offset:37888
ds_read_b64_tr_b16 v[66:67], v8 offset:38144
ds_read_b64_tr_b16 v[68:69], v8 offset:38912
v_mfma_f32_32x32x16_bf16 v[32:47], v[228:231], v[80:83], v[32:47]
ds_read_b64_tr_b16 v[70:71], v8 offset:39168
ds_read_b64_tr_b16 v[72:73], v8 offset:39936
v_mfma_f32_32x32x16_bf16 v[48:63], v[228:231], v[84:87], v[48:63]
ds_read_b64_tr_b16 v[74:75], v8 offset:40192
ds_read_b128 v[236:239], v7 offset:28672
v_mfma_f32_4x4x4_16b_bf16 v[104:107], v[228:229], v[228:229], v[104:107]
v_mfma_f32_4x4x4_16b_bf16 v[108:111], v[230:231], v[230:231], v[108:111]
s_cmp_lg_u32 s4, 0
s_cbranch_scc1 L_G_EPRET2
s_call_b64 s[72:73], L_G_EPCHK
L_G_EPRET2:
s_waitcnt lgkmcnt(0)
v_mfma_f32_32x32x16_bf16 v[16:31], v[232:235], v[88:91], v[16:31]
v_mfma_f32_32x32x16_bf16 v[32:47], v[232:235], v[92:95], v[32:47]
s_barrier
ds_read_b64_tr_b16 v[76:77], v9 offset:0
ds_read_b64_tr_b16 v[78:79], v9 offset:256
ds_read_b64_tr_b16 v[80:81], v9 offset:1024
ds_read_b64_tr_b16 v[82:83], v9 offset:1280
v_mfma_f32_32x32x16_bf16 v[48:63], v[232:235], v[96:99], v[48:63]
ds_read_b64_tr_b16 v[84:85], v9 offset:2048
ds_read_b64_tr_b16 v[86:87], v9 offset:2304
ds_read_b128 v[240:243], v4 offset:57344
v_mfma_f32_4x4x4_16b_bf16 v[104:107], v[232:233], v[232:233], v[104:107]
v_mfma_f32_4x4x4_16b_bf16 v[108:111], v[234:235], v[234:235], v[108:111]
s_waitcnt lgkmcnt(7)
v_mfma_f32_32x32x16_bf16 v[16:31], v[236:239], v[64:67], v[16:31]
ds_read_b64_tr_b16 v[88:89], v9 offset:3072
ds_read_b64_tr_b16 v[90:91], v9 offset:3328
ds_read_b64_tr_b16 v[92:93], v9 offset:4096
v_mfma_f32_32x32x16_bf16 v[32:47], v[236:239], v[68:71], v[32:47]
ds_read_b64_tr_b16 v[94:95], v9 offset:4352
ds_read_b64_tr_b16 v[96:97], v9 offset:5120
v_mfma_f32_32x32x16_bf16 v[48:63], v[236:239], v[72:75], v[48:63]
ds_read_b64_tr_b16 v[98:99], v9 offset:5376
ds_read_b128 v[244:247], v5 offset:57344
v_mfma_f32_4x4x4_16b_bf16 v[104:107], v[236:237], v[236:237], v[104:107]
v_mfma_f32_4x4x4_16b_bf16 v[108:111], v[238:239], v[238:239], v[108:111]
s_waitcnt lgkmcnt(7)
v_mfma_f32_32x32x16_bf16 v[16:31], v[240:243], v[76:79], v[16:31]
ds_read_b64_tr_b16 v[64:65], v9 offset:6144
ds_read_b64_tr_b16 v[66:67], v9 offset:6400
ds_read_b64_tr_b16 v[68:69], v9 offset:7168
v_mfma_f32_32x32x16_bf16 v[32:47], v[240:243], v[80:83], v[32:47]
ds_read_b64_tr_b16 v[70:71], v9 offset:7424
ds_read_b64_tr_b16 v[72:73], v9 offset:8192
v_mfma_f32_32x32x16_bf16 v[48:63], v[240:243], v[84:87], v[48:63]
ds_read_b64_tr_b16 v[74:75], v9 offset:8448
ds_read_b128 v[248:251], v6 offset:57344
v_mfma_f32_4x4x4_16b_bf16 v[104:107], v[240:241], v[240:241], v[104:107]
v_mfma_f32_4x4x4_16b_bf16 v[108:111], v[242:243], v[242:243], v[108:111]
s_waitcnt lgkmcnt(7)
v_mfma_f32_32x32x16_bf16 v[16:31], v[244:247], v[88:91], v[16:31]
ds_read_b64_tr_b16 v[76:77], v9 offset:9216
ds_read_b64_tr_b16 v[78:79], v9 offset:9472
ds_read_b64_tr_b16 v[80:81], v9 offset:10240
v_mfma_f32_32x32x16_bf16 v[32:47], v[244:247], v[92:95], v[32:47]
ds_read_b64_tr_b16 v[82:83], v9 offset:10496
ds_read_b64_tr_b16 v[84:85], v9 offset:11264
v_mfma_f32_32x32x16_bf16 v[48:63], v[244:247], v[96:99], v[48:63]
ds_read_b64_tr_b16 v[86:87], v9 offset:11520
ds_read_b128 v[252:255], v7 offset:57344
v_mfma_f32_4x4x4_16b_bf16 v[104:107], v[244:245], v[244:245], v[104:107]
v_mfma_f32_4x4x4_16b_bf16 v[108:111], v[246:247], v[246:247], v[108:111]
s_waitcnt lgkmcnt(0)
v_mfma_f32_32x32x16_bf16 v[16:31], v[248:251], v[64:67], v[16:31]
v_mfma_f32_32x32x16_bf16 v[32:47], v[248:251], v[68:71], v[32:47]
s_barrier
v_mfma_f32_32x32x16_bf16 v[48:63], v[248:251], v[72:75], v[48:63]
v_mfma_f32_4x4x4_16b_bf16 v[104:107], v[248:249], v[248:249], v[104:107]
v_mfma_f32_4x4x4_16b_bf16 v[108:111], v[250:251], v[250:251], v[108:111]
s_waitcnt lgkmcnt(0)
v_mov_b32 v1, 161024
ds_read_b32 v125, v1
v_mfma_f32_32x32x16_bf16 v[16:31], v[252:255], v[76:79], v[16:31]
v_mfma_f32_32x32x16_bf16 v[32:47], v[252:255], v[80:83], v[32:47]
v_mfma_f32_32x32x16_bf16 v[48:63], v[252:255], v[84:87], v[48:63]
v_mfma_f32_4x4x4_16b_bf16 v[104:107], v[252:253], v[252:253], v[104:107]
v_mfma_f32_4x4x4_16b_bf16 v[108:111], v[254:255], v[254:255], v[108:111]
L_G_P1_END:
s_waitcnt lgkmcnt(0)
v_readfirstlane_b32 s64, v125
s_mov_b32 s66, 0x3eb8aa3b
s_nop 4
s_cmp_eq_u32 s86, 0
s_cbranch_scc0 L_G_NOS0
v_mul_f32 v16, s66, v16
v_mul_f32 v17, s66, v17
v_mul_f32 v18, s66, v18
v_mul_f32 v19, s66, v19
v_mul_f32 v20, s66, v20
v_mul_f32 v21, s66, v21
v_mul_f32 v22, s66, v22
v_mul_f32 v23, s66, v23
v_mul_f32 v24, s66, v24
v_mul_f32 v25, s66, v25
v_mul_f32 v26, s66, v26
v_mul_f32 v27, s66, v27
v_mul_f32 v28, s66, v28
v_mul_f32 v29, s66, v29
v_mul_f32 v30, s66, v30
v_mul_f32 v31, s66, v31
L_G_NOS0:
v_cvt_pk_bf16_f32 v64, v16, v17
v_cvt_pk_bf16_f32 v65, v18, v19
v_cvt_pk_bf16_f32 v66, v20, v21
v_cvt_pk_bf16_f32 v67, v22, v23
v_cvt_pk_bf16_f32 v68, v24, v25
v_cvt_pk_bf16_f32 v69, v26, v27
v_cvt_pk_bf16_f32 v70, v28, v29
v_cvt_pk_bf16_f32 v71, v30, v31
buffer_store_dwordx4 v[64:67], v11, s[28:31], s8 offen sc1
buffer_store_dwordx4 v[68:71], v11, s[28:31], s9 offen sc1
s_cmp_eq_u32 s87, 0
s_cbranch_scc0 L_G_NOS1
v_mul_f32 v32, s66, v32
v_mul_f32 v33, s66, v33
v_mul_f32 v34, s66, v34
v_mul_f32 v35, s66, v35
v_mul_f32 v36, s66, v36
v_mul_f32 v37, s66, v37
v_mul_f32 v38, s66, v38
v_mul_f32 v39, s66, v39
v_mul_f32 v40, s66, v40
v_mul_f32 v41, s66, v41
v_mul_f32 v42, s66, v42
v_mul_f32 v43, s66, v43
v_mul_f32 v44, s66, v44
v_mul_f32 v45, s66, v45
v_mul_f32 v46, s66, v46
v_mul_f32 v47, s66, v47
L_G_NOS1:
v_cvt_pk_bf16_f32 v72, v32, v33
v_cvt_pk_bf16_f32 v73, v34, v35
v_cvt_pk_bf16_f32 v74, v36, v37
v_cvt_pk_bf16_f32 v75, v38, v39
v_cvt_pk_bf16_f32 v76, v40, v41
v_cvt_pk_bf16_f32 v77, v42, v43
v_cvt_pk_bf16_f32 v78, v44, v45
v_cvt_pk_bf16_f32 v79, v46, v47
buffer_store_dwordx4 v[72:75], v15, s[28:31], s10 offen sc1
buffer_store_dwordx4 v[76:79], v15, s[28:31], s11 offen sc1
s_cmp_eq_u32 s88, 0
s_cbranch_scc0 L_G_NOS2
v_mul_f32 v48, s66, v48
v_mul_f32 v49, s66, v49
v_mul_f32 v50, s66, v50
v_mul_f32 v51, s66, v51
v_mul_f32 v52, s66, v52
v_mul_f32 v53, s66, v53
v_mul_f32 v54, s66, v54
v_mul_f32 v55, s66, v55
v_mul_f32 v56, s66, v56
v_mul_f32 v57, s66, v57
v_mul_f32 v58, s66, v58
v_mul_f32 v59, s66, v59
v_mul_f32 v60, s66, v60
v_mul_f32 v61, s66, v61
v_mul_f32 v62, s66, v62
v_mul_f32 v63, s66, v63
L_G_NOS2:
v_cvt_pk_bf16_f32 v80, v48, v49
v_cvt_pk_bf16_f32 v81, v50, v51
v_cvt_pk_bf16_f32 v82, v52, v53
v_cvt_pk_bf16_f32 v83, v54, v55
v_cvt_pk_bf16_f32 v84, v56, v57
v_cvt_pk_bf16_f32 v85, v58, v59
v_cvt_pk_bf16_f32 v86, v60, v61
v_cvt_pk_bf16_f32 v87, v62, v63
buffer_store_dwordx4 v[80:83], v123, s[28:31], s12 offen sc1
buffer_store_dwordx4 v[84:87], v123, s[28:31], s13 offen sc1
s_barrier
ds_read_b64 v[84:85], v122
ds_read_b32 v86, v122 offset:8
v_and_b32 v1, 31, v0
v_lshlrev_b32 v1, 2, v1
s_lshl_b32 s65, s6, 13
s_lshl_b32 s66, s5, 9
s_add_u32 s65, s65, s66
s_lshl_b32 s66, s4, 7
s_add_u32 s65, s65, s66
s_add_u32 s65, s65, 18874368
s_waitcnt lgkmcnt(0)
buffer_store_dword v86, v1, s[28:31], s65 offen sc1
s_mov_b32 s47, 86016
s_mov_b32 s74, 0
s_call_b64 s[72:73], L_CSP
v_and_b32 v1, 1, v0
v_and_b32 v2, 2, v0
v_cmp_eq_u32 vcc, 0, v1
v_cmp_eq_u32 s[70:71], 0, v2
v_add_f32 v16, v104, v108
v_add_f32 v17, v105, v109
v_add_f32 v18, v106, v110
v_add_f32 v19, v107, v111
v_cndmask_b32 v16, v17, v16, vcc
v_cndmask_b32 v18, v19, v18, vcc
v_cndmask_b32 v20, v18, v16, s[70:71]
v_mov_b32 v21, v20
v_mov_b32 v118, v85
s_nop 0
v_permlane32_swap_b32 v20, v21
v_add_f32 v20, v20, v21
v_mul_f32 v20, 0x3b000000, v20
v_fma_f32 v20, -v84, v84, v20
v_max_f32 v20, 0, v20
v_add_f32 v20, 0x3727c5ac, v20
v_rsq_f32 v12, v20
s_nop 0
v_mul_f32 v13, -v84, v12
ds_write_b64 v122, v[12:13] offset:8
s_waitcnt vmcnt(0) lgkmcnt(0)
s_lshl_b32 s65, s5, 4
s_add_u32 s65, s65, s6
s_lshl_b32 s65, s65, 4
s_add_u32 s65, s65, s4
s_lshl_b32 s65, s65, 2
s_add_u32 s65, s65, 19922944
v_mov_b32 v1, s64
v_mov_b32 v2, 0

buffer_store_dword v1, v2, s[28:31], s65 offen sc1
s_barrier
s_sub_u32 s99, s96, s7
s_and_b32 s99, s99, 7
s_mov_b32 s100, s96
s_lshl_b32 s97, s4, 11
s_add_u32 s97, s97, 0
s_mul_i32 s98, s4, 57344
s_lshl_b32 s65, s79, 6
s_add_u32 s98, s98, s65
s_add_u32 s99, s99, 1
s_and_b32 s99, s99, 7
s_add_u32 s100, s100, 1
s_and_b32 s100, s100, 7
v_add_u32 v11, 86016, v102
s_setprio 1
s_call_b64 s[72:73], L_TILEW
s_setprio 0
s_waitcnt vmcnt(0)
s_barrier
s_mov_b32 s47, 0
s_mov_b32 s74, 256
s_call_b64 s[72:73], L_CSP
s_mov_b32 s47, 0
s_call_b64 s[72:73], L_EPI
s_barrier
s_mov_b32 s65, s78
s_lshl_b32 s65, s65, 11
s_lshl_b32 s66, s5, 2
s_add_u32 s66, s66, s4
s_mul_i32 s66, s66, 114688
s_add_u32 s65, s65, s66
s_add_u32 s65, s65, 8388608
buffer_store_dwordx4 v[104:107], v14, s[28:31], s65 offen sc1
buffer_store_dwordx4 v[108:111], v14, s[28:31], s65 offen offset:1024 sc1
s_cmp_eq_u32 s80, 0
s_cbranch_scc1 L_G_NOC1
v_add_u32 v11, 0, v102
s_setprio 1
s_call_b64 s[72:73], L_TILE
s_setprio 0
L_G_NOC1:
s_barrier
s_cmp_eq_u32 s80, 0
s_cbranch_scc1 L_G_NOC2
s_setprio 2
s_mov_b32 s47, 256
s_call_b64 s[72:73], L_EPI
L_G_NOC2:
s_setprio 0
s_mov_b32 s47, 102400
s_mov_b32 s74, 16
s_call_b64 s[72:73], L_DMAKV
s_mov_b32 s47, 0
s_mov_b32 s74, 32
s_call_b64 s[72:73], L_DMAKV
s_mov_b32 s47, 16384
s_mov_b32 s74, 48
s_call_b64 s[72:73], L_DMAKV
s_cmp_eq_u32 s80, 0
s_cbranch_scc1 L_G_NOC3
s_mov_b32 s65, s79
s_lshl_b32 s65, s65, 11
s_lshl_b32 s66, s5, 2
s_add_u32 s66, s66, s4
s_mul_i32 s66, s66, 114688
s_add_u32 s65, s65, s66
s_add_u32 s65, s65, 8388608
buffer_store_dwordx4 v[104:107], v14, s[28:31], s65 offen sc1
buffer_store_dwordx4 v[108:111], v14, s[28:31], s65 offen offset:1024 sc1
L_G_NOC3:
s_waitcnt vmcnt(0)
s_barrier
s_cmp_eq_u32 s4, 0
s_cbranch_scc0 L_G_NF2
s_lshl_b32 s65, s5, 4
s_add_u32 s65, s65, s6
s_lshl_b32 s65, s65, 6
s_add_u32 s65, s65, 19988480
v_mov_b32 v1, s64
v_mov_b32 v2, 0
buffer_store_dword v1, v2, s[28:31], s65 offen sc1
L_G_NF2:
s_mov_b32 s74, s94
s_mov_b32 s75, s95
v_mov_b32 v4, v112
v_mov_b32 v5, v113
v_mov_b32 v6, v114
v_mov_b32 v7, v115
v_mov_b32 v8, v116
v_mov_b32 v9, v126
v_mov_b32 v3, v120
v_mov_b32 v2, v121
s_lshl_b32 s68, s4, 17
s_lshl_b32 s66, s85, 7
s_add_u32 s68, s68, s66
s_add_u32 s65, s68, 0
s_add_u32 m0, s76, 0
s_nop 0
buffer_load_dwordx4 v4, s[24:27], s65 offen  lds
buffer_load_dwordx4 v5, s[24:27], s65 offen offset:1024  lds
s_add_u32 s65, s68, 16384
s_add_u32 m0, s76, 2048
s_nop 0
buffer_load_dwordx4 v4, s[24:27], s65 offen  lds
buffer_load_dwordx4 v5, s[24:27], s65 offen offset:1024  lds
s_add_u32 s65, s68, 32768
s_add_u32 m0, s76, 4096
s_nop 0
buffer_load_dwordx4 v4, s[24:27], s65 offen  lds
buffer_load_dwordx4 v5, s[24:27], s65 offen offset:1024  lds
s_waitcnt vmcnt(4)
ds_read_b64_tr_b16 v[128:129], v6 offset:0
ds_read_b64_tr_b16 v[130:131], v6 offset:512
ds_read_b64_tr_b16 v[132:133], v7 offset:0
ds_read_b64_tr_b16 v[134:135], v7 offset:512
s_waitcnt lgkmcnt(0)
s_add_u32 s65, s68, 49152
s_add_u32 m0, s76, 0
s_nop 0
buffer_load_dwordx4 v4, s[24:27], s65 offen  lds
buffer_load_dwordx4 v5, s[24:27], s65 offen offset:1024  lds
s_waitcnt vmcnt(4)
ds_read_b64_tr_b16 v[136:137], v6 offset:2048
ds_read_b64_tr_b16 v[138:139], v6 offset:2560
ds_read_b64_tr_b16 v[140:141], v7 offset:2048
ds_read_b64_tr_b16 v[142:143], v7 offset:2560
s_waitcnt lgkmcnt(0)
s_add_u32 s65, s68, 65536
s_add_u32 m0, s76, 2048
s_nop 0
buffer_load_dwordx4 v4, s[24:27], s65 offen  lds
buffer_load_dwordx4 v5, s[24:27], s65 offen offset:1024  lds
s_waitcnt vmcnt(4)
ds_read_b64_tr_b16 v[144:145], v6 offset:4096
ds_read_b64_tr_b16 v[146:147], v6 offset:4608
ds_read_b64_tr_b16 v[148:149], v7 offset:4096
ds_read_b64_tr_b16 v[150:151], v7 offset:4608
s_waitcnt lgkmcnt(0)
s_add_u32 s65, s68, 81920
s_add_u32 m0, s76, 4096
s_nop 0
buffer_load_dwordx4 v4, s[24:27], s65 offen  lds
buffer_load_dwordx4 v5, s[24:27], s65 offen offset:1024  lds
s_waitcnt vmcnt(4)
ds_read_b64_tr_b16 v[152:153], v6 offset:0
ds_read_b64_tr_b16 v[154:155], v6 offset:512
ds_read_b64_tr_b16 v[156:157], v7 offset:0
ds_read_b64_tr_b16 v[158:159], v7 offset:512
s_waitcnt lgkmcnt(0)
s_add_u32 s65, s68, 98304
s_add_u32 m0, s76, 0
s_nop 0
buffer_load_dwordx4 v4, s[24:27], s65 offen  lds
buffer_load_dwordx4 v5, s[24:27], s65 offen offset:1024  lds
s_waitcnt vmcnt(4)
ds_read_b64_tr_b16 v[160:161], v6 offset:2048
ds_read_b64_tr_b16 v[162:163], v6 offset:2560
ds_read_b64_tr_b16 v[164:165], v7 offset:2048
ds_read_b64_tr_b16 v[166:167], v7 offset:2560
s_waitcnt lgkmcnt(0)
s_add_u32 s65, s68, 114688
s_add_u32 m0, s76, 2048
s_nop 0
buffer_load_dwordx4 v4, s[24:27], s65 offen  lds
buffer_load_dwordx4 v5, s[24:27], s65 offen offset:1024  lds
s_waitcnt vmcnt(4)
ds_read_b64_tr_b16 v[168:169], v6 offset:4096
ds_read_b64_tr_b16 v[170:171], v6 offset:4608
ds_read_b64_tr_b16 v[172:173], v7 offset:4096
ds_read_b64_tr_b16 v[174:175], v7 offset:4608
s_waitcnt vmcnt(2)
ds_read_b64_tr_b16 v[176:177], v6 offset:0
ds_read_b64_tr_b16 v[178:179], v6 offset:512
ds_read_b64_tr_b16 v[180:181], v7 offset:0
ds_read_b64_tr_b16 v[182:183], v7 offset:512
s_waitcnt vmcnt(0)
ds_read_b64_tr_b16 v[184:185], v6 offset:2048
ds_read_b64_tr_b16 v[186:187], v6 offset:2560
ds_read_b64_tr_b16 v[188:189], v7 offset:2048
ds_read_b64_tr_b16 v[190:191], v7 offset:2560
s_waitcnt lgkmcnt(0)
s_mov_b32 s46, 100000
buffer_load_dword v119, v3, s[28:31], 0 offen sc1
L_P2:
s_waitcnt vmcnt(0)
v_cmp_ne_u32 vcc, s64, v119
s_cbranch_vccz L_P2_ok
s_sub_u32 s46, s46, 1
s_cbranch_scc1 L_P2_ok
buffer_load_dword v119, v3, s[28:31], 0 offen sc1
s_branch L_P2
L_P2_ok:
s_lshl_b32 s65, s84, 8
s_add_u32 s65, s65, 18874368
buffer_load_dword v10, v2, s[28:31], s65 offen sc1
s_and_b32 s65, s84, 3
s_mul_i32 s65, s65, 7
s_mul_i32 s66, s85, 7
s_lshr_b32 s66, s66, 1
s_add_u32 s77, s65, s66
s_cmp_ge_u32 s77, 28
s_cselect_b32 s65, 28, 0
s_sub_u32 s77, s77, s65
s_lshl_b32 s65, s77, 14
s_add_u32 s65, s65, s74
s_lshl_b32 s66, s77, 10
s_add_u32 s66, s66, s75
s_add_u32 s77, s77, 1
s_cmp_eq_u32 s77, 28
s_cmov_b32 s77, 0
s_add_u32 m0, s76, 0
s_nop 0
buffer_load_dwordx4 v4, s[20:23], s65 offen  lds
buffer_load_dwordx4 v5, s[20:23], s65 offen offset:1024  lds
buffer_load_dwordx4 v[96:99], v8, s[28:31], s66 offen sc1
buffer_load_dwordx4 v[100:103], v9, s[28:31], s66 offen sc1
s_lshl_b32 s65, s77, 14
s_add_u32 s65, s65, s74
s_lshl_b32 s66, s77, 10
s_add_u32 s66, s66, s75
s_add_u32 s77, s77, 1
s_cmp_eq_u32 s77, 28
s_cmov_b32 s77, 0
s_add_u32 m0, s76, 2048
s_nop 0
buffer_load_dwordx4 v4, s[20:23], s65 offen  lds
buffer_load_dwordx4 v5, s[20:23], s65 offen offset:1024  lds
buffer_load_dwordx4 v[104:107], v8, s[28:31], s66 offen sc1
buffer_load_dwordx4 v[108:111], v9, s[28:31], s66 offen sc1
s_waitcnt vmcnt(6)
ds_read_b64_tr_b16 v[80:81], v6 offset:0
ds_read_b64_tr_b16 v[82:83], v6 offset:512
ds_read_b64_tr_b16 v[84:85], v7 offset:0
ds_read_b64_tr_b16 v[86:87], v7 offset:512
s_lshl_b32 s65, s77, 14
s_add_u32 s65, s65, s74
s_lshl_b32 s66, s77, 10
s_add_u32 s66, s66, s75
s_add_u32 s77, s77, 1
s_cmp_eq_u32 s77, 28
s_cmov_b32 s77, 0
s_waitcnt lgkmcnt(0)
s_add_u32 m0, s76, 0
s_nop 0
buffer_load_dwordx4 v4, s[20:23], s65 offen  lds
buffer_load_dwordx4 v5, s[20:23], s65 offen offset:1024  lds
buffer_load_dwordx4 v[112:115], v8, s[28:31], s66 offen sc1
buffer_load_dwordx4 v[116:119], v9, s[28:31], s66 offen sc1
s_waitcnt vmcnt(6)
v_mfma_f32_32x32x16_bf16 v[16:31], v[80:83], v[96:99], 0
ds_read_b64_tr_b16 v[88:89], v6 offset:2048
ds_read_b64_tr_b16 v[90:91], v6 offset:2560
ds_read_b64_tr_b16 v[92:93], v7 offset:2048
ds_read_b64_tr_b16 v[94:95], v7 offset:2560
v_mfma_f32_32x32x16_bf16 v[32:47], v[84:87], v[96:99], 0
v_mfma_f32_32x32x16_bf16 v[48:63], v[80:83], v[100:103], 0
v_mfma_f32_32x32x16_bf16 v[64:79], v[84:87], v[100:103], 0
s_lshl_b32 s65, s77, 14
s_add_u32 s65, s65, s74
s_lshl_b32 s66, s77, 10
s_add_u32 s66, s66, s75
s_add_u32 s77, s77, 1
s_cmp_eq_u32 s77, 28
s_cmov_b32 s77, 0
s_waitcnt lgkmcnt(0)
s_add_u32 m0, s76, 2048
s_nop 0
buffer_load_dwordx4 v4, s[20:23], s65 offen  lds
buffer_load_dwordx4 v5, s[20:23], s65 offen offset:1024  lds
buffer_load_dwordx4 v[120:123], v8, s[28:31], s66 offen sc1
buffer_load_dwordx4 v[124:127], v9, s[28:31], s66 offen sc1
s_waitcnt vmcnt(6)
v_mfma_f32_32x32x16_bf16 v[16:31], v[88:91], v[104:107], v[16:31]
ds_read_b64_tr_b16 v[80:81], v6 offset:0
ds_read_b64_tr_b16 v[82:83], v6 offset:512
ds_read_b64_tr_b16 v[84:85], v7 offset:0
ds_read_b64_tr_b16 v[86:87], v7 offset:512
v_mfma_f32_32x32x16_bf16 v[32:47], v[92:95], v[104:107], v[32:47]
v_mfma_f32_32x32x16_bf16 v[48:63], v[88:91], v[108:111], v[48:63]
v_mfma_f32_32x32x16_bf16 v[64:79], v[92:95], v[108:111], v[64:79]
s_lshl_b32 s65, s77, 14
s_add_u32 s65, s65, s74
s_lshl_b32 s66, s77, 10
s_add_u32 s66, s66, s75
s_add_u32 s77, s77, 1
s_cmp_eq_u32 s77, 28
s_cmov_b32 s77, 0
s_waitcnt lgkmcnt(0)
s_add_u32 m0, s76, 0
s_nop 0
buffer_load_dwordx4 v4, s[20:23], s65 offen  lds
buffer_load_dwordx4 v5, s[20:23], s65 offen offset:1024  lds
buffer_load_dwordx4 v[96:99], v8, s[28:31], s66 offen sc1
buffer_load_dwordx4 v[100:103], v9, s[28:31], s66 offen sc1
s_waitcnt vmcnt(6)
v_mfma_f32_32x32x16_bf16 v[16:31], v[80:83], v[112:115], v[16:31]
ds_read_b64_tr_b16 v[88:89], v6 offset:2048
ds_read_b64_tr_b16 v[90:91], v6 offset:2560
ds_read_b64_tr_b16 v[92:93], v7 offset:2048
ds_read_b64_tr_b16 v[94:95], v7 offset:2560
v_mfma_f32_32x32x16_bf16 v[32:47], v[84:87], v[112:115], v[32:47]
v_mfma_f32_32x32x16_bf16 v[48:63], v[80:83], v[116:119], v[48:63]
v_mfma_f32_32x32x16_bf16 v[64:79], v[84:87], v[116:119], v[64:79]
s_lshl_b32 s65, s77, 14
s_add_u32 s65, s65, s74
s_lshl_b32 s66, s77, 10
s_add_u32 s66, s66, s75
s_add_u32 s77, s77, 1
s_cmp_eq_u32 s77, 28
s_cmov_b32 s77, 0
s_waitcnt lgkmcnt(0)
s_add_u32 m0, s76, 2048
s_nop 0
buffer_load_dwordx4 v4, s[20:23], s65 offen  lds
buffer_load_dwordx4 v5, s[20:23], s65 offen offset:1024  lds
buffer_load_dwordx4 v[104:107], v8, s[28:31], s66 offen sc1
buffer_load_dwordx4 v[108:111], v9, s[28:31], s66 offen sc1
s_waitcnt vmcnt(6)
v_mfma_f32_32x32x16_bf16 v[16:31], v[88:91], v[120:123], v[16:31]
ds_read_b64_tr_b16 v[80:81], v6 offset:0
ds_read_b64_tr_b16 v[82:83], v6 offset:512
ds_read_b64_tr_b16 v[84:85], v7 offset:0
ds_read_b64_tr_b16 v[86:87], v7 offset:512
v_mfma_f32_32x32x16_bf16 v[32:47], v[92:95], v[120:123], v[32:47]
v_mfma_f32_32x32x16_bf16 v[48:63], v[88:91], v[124:127], v[48:63]
v_mfma_f32_32x32x16_bf16 v[64:79], v[92:95], v[124:127], v[64:79]
s_lshl_b32 s65, s77, 14
s_add_u32 s65, s65, s74
s_lshl_b32 s66, s77, 10
s_add_u32 s66, s66, s75
s_add_u32 s77, s77, 1
s_cmp_eq_u32 s77, 28
s_cmov_b32 s77, 0
s_waitcnt lgkmcnt(0)
s_add_u32 m0, s76, 0
s_nop 0
buffer_load_dwordx4 v4, s[20:23], s65 offen  lds
buffer_load_dwordx4 v5, s[20:23], s65 offen offset:1024  lds
buffer_load_dwordx4 v[112:115], v8, s[28:31], s66 offen sc1
buffer_load_dwordx4 v[116:119], v9, s[28:31], s66 offen sc1
s_mov_b32 s86, 4
L_G2:
s_waitcnt vmcnt(6)
v_mfma_f32_32x32x16_bf16 v[16:31], v[80:83], v[96:99], v[16:31]
ds_read_b64_tr_b16 v[88:89], v6 offset:2048
ds_read_b64_tr_b16 v[90:91], v6 offset:2560
ds_read_b64_tr_b16 v[92:93], v7 offset:2048
ds_read_b64_tr_b16 v[94:95], v7 offset:2560
v_mfma_f32_32x32x16_bf16 v[32:47], v[84:87], v[96:99], v[32:47]
v_mfma_f32_32x32x16_bf16 v[48:63], v[80:83], v[100:103], v[48:63]
v_mfma_f32_32x32x16_bf16 v[64:79], v[84:87], v[100:103], v[64:79]
s_lshl_b32 s65, s77, 14
s_add_u32 s65, s65, s74
s_lshl_b32 s66, s77, 10
s_add_u32 s66, s66, s75
s_add_u32 s77, s77, 1
s_cmp_eq_u32 s77, 28
s_cmov_b32 s77, 0
s_waitcnt lgkmcnt(0)
s_add_u32 m0, s76, 2048
s_nop 0
buffer_load_dwordx4 v4, s[20:23], s65 offen  lds
buffer_load_dwordx4 v5, s[20:23], s65 offen offset:1024  lds
buffer_load_dwordx4 v[120:123], v8, s[28:31], s66 offen sc1
buffer_load_dwordx4 v[124:127], v9, s[28:31], s66 offen sc1
s_waitcnt vmcnt(6)
v_mfma_f32_32x32x16_bf16 v[16:31], v[88:91], v[104:107], v[16:31]
ds_read_b64_tr_b16 v[80:81], v6 offset:0
ds_read_b64_tr_b16 v[82:83], v6 offset:512
ds_read_b64_tr_b16 v[84:85], v7 offset:0
ds_read_b64_tr_b16 v[86:87], v7 offset:512
v_mfma_f32_32x32x16_bf16 v[32:47], v[92:95], v[104:107], v[32:47]
v_mfma_f32_32x32x16_bf16 v[48:63], v[88:91], v[108:111], v[48:63]
v_mfma_f32_32x32x16_bf16 v[64:79], v[92:95], v[108:111], v[64:79]
s_lshl_b32 s65, s77, 14
s_add_u32 s65, s65, s74
s_lshl_b32 s66, s77, 10
s_add_u32 s66, s66, s75
s_add_u32 s77, s77, 1
s_cmp_eq_u32 s77, 28
s_cmov_b32 s77, 0
s_waitcnt lgkmcnt(0)
s_add_u32 m0, s76, 0
s_nop 0
buffer_load_dwordx4 v4, s[20:23], s65 offen  lds
buffer_load_dwordx4 v5, s[20:23], s65 offen offset:1024  lds
buffer_load_dwordx4 v[96:99], v8, s[28:31], s66 offen sc1
buffer_load_dwordx4 v[100:103], v9, s[28:31], s66 offen sc1
s_waitcnt vmcnt(6)
v_mfma_f32_32x32x16_bf16 v[16:31], v[80:83], v[112:115], v[16:31]
ds_read_b64_tr_b16 v[88:89], v6 offset:2048
ds_read_b64_tr_b16 v[90:91], v6 offset:2560
ds_read_b64_tr_b16 v[92:93], v7 offset:2048
ds_read_b64_tr_b16 v[94:95], v7 offset:2560
v_mfma_f32_32x32x16_bf16 v[32:47], v[84:87], v[112:115], v[32:47]
v_mfma_f32_32x32x16_bf16 v[48:63], v[80:83], v[116:119], v[48:63]
v_mfma_f32_32x32x16_bf16 v[64:79], v[84:87], v[116:119], v[64:79]
s_lshl_b32 s65, s77, 14
s_add_u32 s65, s65, s74
s_lshl_b32 s66, s77, 10
s_add_u32 s66, s66, s75
s_add_u32 s77, s77, 1
s_cmp_eq_u32 s77, 28
s_cmov_b32 s77, 0
s_waitcnt lgkmcnt(0)
s_add_u32 m0, s76, 2048
s_nop 0
buffer_load_dwordx4 v4, s[20:23], s65 offen  lds
buffer_load_dwordx4 v5, s[20:23], s65 offen offset:1024  lds
buffer_load_dwordx4 v[104:107], v8, s[28:31], s66 offen sc1
buffer_load_dwordx4 v[108:111], v9, s[28:31], s66 offen sc1
s_waitcnt vmcnt(6)
v_mfma_f32_32x32x16_bf16 v[16:31], v[88:91], v[120:123], v[16:31]
ds_read_b64_tr_b16 v[80:81], v6 offset:0
ds_read_b64_tr_b16 v[82:83], v6 offset:512
ds_read_b64_tr_b16 v[84:85], v7 offset:0
ds_read_b64_tr_b16 v[86:87], v7 offset:512
v_mfma_f32_32x32x16_bf16 v[32:47], v[92:95], v[120:123], v[32:47]
v_mfma_f32_32x32x16_bf16 v[48:63], v[88:91], v[124:127], v[48:63]
v_mfma_f32_32x32x16_bf16 v[64:79], v[92:95], v[124:127], v[64:79]
s_lshl_b32 s65, s77, 14
s_add_u32 s65, s65, s74
s_lshl_b32 s66, s77, 10
s_add_u32 s66, s66, s75
s_add_u32 s77, s77, 1
s_cmp_eq_u32 s77, 28
s_cmov_b32 s77, 0
s_waitcnt lgkmcnt(0)
s_add_u32 m0, s76, 0
s_nop 0
buffer_load_dwordx4 v4, s[20:23], s65 offen  lds
buffer_load_dwordx4 v5, s[20:23], s65 offen offset:1024  lds
buffer_load_dwordx4 v[112:115], v8, s[28:31], s66 offen sc1
buffer_load_dwordx4 v[116:119], v9, s[28:31], s66 offen sc1
s_sub_u32 s86, s86, 1
s_cbranch_scc0 L_G2
s_waitcnt vmcnt(6)
ds_read_b64_tr_b16 v[88:89], v6 offset:2048
ds_read_b64_tr_b16 v[90:91], v6 offset:2560
ds_read_b64_tr_b16 v[92:93], v7 offset:2048
ds_read_b64_tr_b16 v[94:95], v7 offset:2560
s_lshl_b32 s65, s77, 14
s_add_u32 s65, s65, s74
s_lshl_b32 s66, s77, 10
s_add_u32 s66, s66, s75
s_add_u32 s77, s77, 1
s_cmp_eq_u32 s77, 28
s_cmov_b32 s77, 0
s_waitcnt lgkmcnt(0)
s_add_u32 m0, s76, 2048
s_nop 0
buffer_load_dwordx4 v4, s[20:23], s65 offen  lds
buffer_load_dwordx4 v5, s[20:23], s65 offen offset:1024  lds
buffer_load_dwordx4 v[120:123], v8, s[28:31], s66 offen sc1
buffer_load_dwordx4 v[124:127], v9, s[28:31], s66 offen sc1
s_lshl_b32 s65, s84, 5
s_lshl_b32 s66, s4, 3
s_add_u32 s65, s65, s66
s_lshl_b32 s65, s65, 6
s_add_u32 s65, s65, 20054016
v_and_b32 v1, 7, v0
v_lshlrev_b32 v1, 6, v1
v_add_u32 v3, s65, v1
s_mov_b32 s46, 100000
buffer_load_dword v1, v3, s[28:31], 0 offen sc1
L_P3P:
s_waitcnt vmcnt(0)
v_cmp_ne_u32 vcc, s64, v1
s_cbranch_vccz L_P3P_ok
s_sub_u32 s46, s46, 1
s_cbranch_scc1 L_P3P_ok
buffer_load_dword v1, v3, s[28:31], 0 offen sc1
s_branch L_P3P
L_P3P_ok:
v_sub_f32 v10, 1.0, v10
s_lshr_b32 s65, s4, 1
s_lshl_b32 s65, s65, 15
v_add_u32 v8, s65, v14
v_xor_b32 v9, 0x8000, v8
s_lshl_b32 s75, s84, 16
s_lshl_b32 s66, s4, 13
s_add_u32 s75, s75, s66
s_add_u32 s75, s75, 16777216
s_add_u32 s77, s75, 4096
s_and_b32 s65, s4, 1
s_lshl_b32 s65, s65, 7
s_add_u32 s65, s65, 163584
v_and_b32 v1, 32, v0
v_add_u32 v3, s65, v1
s_lshl_b32 s74, s84, 16
s_lshr_b32 s65, s4, 1
s_lshl_b32 s65, s65, 15
s_add_u32 s74, s74, s65
s_lshl_b32 s65, s85, 7
s_add_u32 s74, s74, s65
s_and_b32 s65, s4, 1
s_lshl_b32 s65, s65, 6
s_add_u32 s74, s74, s65
s_barrier
v_mfma_f32_32x32x16_bf16 v[16:31], v[80:83], v[96:99], v[16:31]
v_mfma_f32_32x32x16_bf16 v[32:47], v[84:87], v[96:99], v[32:47]
v_mfma_f32_32x32x16_bf16 v[48:63], v[80:83], v[100:103], v[48:63]
v_mfma_f32_32x32x16_bf16 v[64:79], v[84:87], v[100:103], v[64:79]
ds_read_b64_tr_b16 v[80:81], v6 offset:0
ds_read_b64_tr_b16 v[82:83], v6 offset:512
ds_read_b64_tr_b16 v[84:85], v7 offset:0
ds_read_b64_tr_b16 v[86:87], v7 offset:512
v_mfma_f32_32x32x16_bf16 v[16:31], v[88:91], v[104:107], v[16:31]
v_mfma_f32_32x32x16_bf16 v[32:47], v[92:95], v[104:107], v[32:47]
v_mfma_f32_32x32x16_bf16 v[48:63], v[88:91], v[108:111], v[48:63]
v_mfma_f32_32x32x16_bf16 v[64:79], v[92:95], v[108:111], v[64:79]
ds_read_b64_tr_b16 v[88:89], v6 offset:2048
ds_read_b64_tr_b16 v[90:91], v6 offset:2560
ds_read_b64_tr_b16 v[92:93], v7 offset:2048
ds_read_b64_tr_b16 v[94:95], v7 offset:2560
s_waitcnt lgkmcnt(4)
v_mfma_f32_32x32x16_bf16 v[16:31], v[80:83], v[112:115], v[16:31]
v_mfma_f32_32x32x16_bf16 v[32:47], v[84:87], v[112:115], v[32:47]
v_mfma_f32_32x32x16_bf16 v[48:63], v[80:83], v[116:119], v[48:63]
v_mfma_f32_32x32x16_bf16 v[64:79], v[84:87], v[116:119], v[64:79]
s_waitcnt lgkmcnt(0)
v_mfma_f32_32x32x16_bf16 v[16:31], v[88:91], v[120:123], v[16:31]
v_mfma_f32_32x32x16_bf16 v[32:47], v[92:95], v[120:123], v[32:47]
v_mfma_f32_32x32x16_bf16 v[48:63], v[88:91], v[124:127], v[48:63]
v_mfma_f32_32x32x16_bf16 v[64:79], v[92:95], v[124:127], v[64:79]
ds_read_b128 v[80:83], v3 offset:0
ds_read_b128 v[84:87], v3 offset:16
ds_read_b128 v[88:91], v3 offset:64
ds_read_b128 v[92:95], v3 offset:80
s_xor_b32 s65, s4, 1
s_mul_i32 s65, s65, 12288
s_add_u32 s65, s65, 0
v_add_u32 v120, s65, v14
s_xor_b32 s65, s4, 2
s_mul_i32 s65, s65, 12288
s_add_u32 s65, s65, 4096
v_add_u32 v121, s65, v14
s_xor_b32 s65, s4, 3
s_mul_i32 s65, s65, 12288
s_add_u32 s65, s65, 8192
v_add_u32 v122, s65, v14
s_mul_i32 s65, s4, 12288
v_add_u32 v123, s65, v14
v_and_b32 v1, 31, v0
v_lshlrev_b32 v1, 10, v1
v_lshrrev_b32 v2, 5, v0
v_lshl_add_u32 v124, v2, 4, v1
s_mov_b32 s46, 100000
s_mov_b32 s86, 0
L_P3:
s_bitcmp1_b32 s86, 0
s_cbranch_scc1 L_P3_1
buffer_load_dwordx4 v[192:195], v8, s[28:31], s75 offen offset:0 sc1
buffer_load_dwordx4 v[196:199], v9, s[28:31], s75 offen offset:0 sc1
buffer_load_dwordx4 v[200:203], v8, s[28:31], s75 offen offset:1024 sc1
buffer_load_dwordx4 v[204:207], v9, s[28:31], s75 offen offset:1024 sc1
buffer_load_dwordx4 v[208:211], v8, s[28:31], s75 offen offset:2048 sc1
buffer_load_dwordx4 v[212:215], v9, s[28:31], s75 offen offset:2048 sc1
buffer_load_dwordx4 v[216:219], v8, s[28:31], s75 offen offset:3072 sc1
buffer_load_dwordx4 v[220:223], v9, s[28:31], s75 offen offset:3072 sc1
L_P3_1:
s_bitcmp1_b32 s86, 1
s_cbranch_scc1 L_P3_2
buffer_load_dwordx4 v[224:227], v8, s[28:31], s77 offen offset:0 sc1
buffer_load_dwordx4 v[228:231], v9, s[28:31], s77 offen offset:0 sc1
buffer_load_dwordx4 v[232:235], v8, s[28:31], s77 offen offset:1024 sc1
buffer_load_dwordx4 v[236:239], v9, s[28:31], s77 offen offset:1024 sc1
buffer_load_dwordx4 v[240:243], v8, s[28:31], s77 offen offset:2048 sc1
buffer_load_dwordx4 v[244:247], v9, s[28:31], s77 offen offset:2048 sc1
buffer_load_dwordx4 v[248:251], v8, s[28:31], s77 offen offset:3072 sc1
buffer_load_dwordx4 v[252:255], v9, s[28:31], s77 offen offset:3072 sc1
L_P3_2:
s_bitcmp1_b32 s86, 0
s_cbranch_scc1 L_P3_3
s_bitcmp1_b32 s86, 1
s_cbranch_scc1 L_P3_2A
s_waitcnt vmcnt(8)
L_P3_2A2:
v_max3_u32 v1, v192, v193, v194
v_max3_u32 v2, v195, v196, v197
v_max3_u32 v1, v1, v198, v199
v_max3_u32 v2, v2, v200, v201
v_max3_u32 v1, v1, v202, v203
v_max3_u32 v2, v2, v204, v205
v_max3_u32 v1, v1, v206, v207
v_max3_u32 v2, v2, v208, v209
v_max3_u32 v1, v1, v210, v211
v_max3_u32 v2, v2, v212, v213
v_max3_u32 v1, v1, v214, v215
v_max3_u32 v2, v2, v216, v217
v_max3_u32 v1, v1, v218, v219
v_max3_u32 v2, v2, v220, v221
v_max3_u32 v1, v1, v222, v223
v_max_u32 v1, v1, v2
v_cmp_eq_u32 vcc, -1, v1
s_cbranch_vccnz L_P3_3
v_mfma_f32_32x32x16_bf16 v[16:31], v[128:131], v[192:195], v[16:31]
v_mfma_f32_32x32x16_bf16 v[32:47], v[132:135], v[192:195], v[32:47]
v_mfma_f32_32x32x16_bf16 v[48:63], v[128:131], v[196:199], v[48:63]
v_mfma_f32_32x32x16_bf16 v[64:79], v[132:135], v[196:199], v[64:79]
v_mfma_f32_32x32x16_bf16 v[16:31], v[136:139], v[200:203], v[16:31]
v_mfma_f32_32x32x16_bf16 v[32:47], v[140:143], v[200:203], v[32:47]
v_mfma_f32_32x32x16_bf16 v[48:63], v[136:139], v[204:207], v[48:63]
v_mfma_f32_32x32x16_bf16 v[64:79], v[140:143], v[204:207], v[64:79]
v_mfma_f32_32x32x16_bf16 v[16:31], v[144:147], v[208:211], v[16:31]
v_mfma_f32_32x32x16_bf16 v[32:47], v[148:151], v[208:211], v[32:47]
v_mfma_f32_32x32x16_bf16 v[48:63], v[144:147], v[212:215], v[48:63]
v_mfma_f32_32x32x16_bf16 v[64:79], v[148:151], v[212:215], v[64:79]
v_mfma_f32_32x32x16_bf16 v[16:31], v[152:155], v[216:219], v[16:31]
v_mfma_f32_32x32x16_bf16 v[32:47], v[156:159], v[216:219], v[32:47]
v_mfma_f32_32x32x16_bf16 v[48:63], v[152:155], v[220:223], v[48:63]
v_mfma_f32_32x32x16_bf16 v[64:79], v[156:159], v[220:223], v[64:79]
s_bitset1_b32 s86, 0
L_P3_3:
s_waitcnt vmcnt(0)
s_bitcmp1_b32 s86, 1
s_cbranch_scc1 L_P3_4
v_max3_u32 v1, v224, v225, v226
v_max3_u32 v2, v227, v228, v229
v_max3_u32 v1, v1, v230, v231
v_max3_u32 v2, v2, v232, v233
v_max3_u32 v1, v1, v234, v235
v_max3_u32 v2, v2, v236, v237
v_max3_u32 v1, v1, v238, v239
v_max3_u32 v2, v2, v240, v241
v_max3_u32 v1, v1, v242, v243
v_max3_u32 v2, v2, v244, v245
v_max3_u32 v1, v1, v246, v247
v_max3_u32 v2, v2, v248, v249
v_max3_u32 v1, v1, v250, v251
v_max3_u32 v2, v2, v252, v253
v_max3_u32 v1, v1, v254, v255
v_max_u32 v1, v1, v2
v_cmp_eq_u32 vcc, -1, v1
s_cbranch_vccnz L_P3_4
v_mfma_f32_32x32x16_bf16 v[16:31], v[160:163], v[224:227], v[16:31]
v_mfma_f32_32x32x16_bf16 v[32:47], v[164:167], v[224:227], v[32:47]
v_mfma_f32_32x32x16_bf16 v[48:63], v[160:163], v[228:231], v[48:63]
v_mfma_f32_32x32x16_bf16 v[64:79], v[164:167], v[228:231], v[64:79]
v_mfma_f32_32x32x16_bf16 v[16:31], v[168:171], v[232:235], v[16:31]
v_mfma_f32_32x32x16_bf16 v[32:47], v[172:175], v[232:235], v[32:47]
v_mfma_f32_32x32x16_bf16 v[48:63], v[168:171], v[236:239], v[48:63]
v_mfma_f32_32x32x16_bf16 v[64:79], v[172:175], v[236:239], v[64:79]
v_mfma_f32_32x32x16_bf16 v[16:31], v[176:179], v[240:243], v[16:31]
v_mfma_f32_32x32x16_bf16 v[32:47], v[180:183], v[240:243], v[32:47]
v_mfma_f32_32x32x16_bf16 v[48:63], v[176:179], v[244:247], v[48:63]
v_mfma_f32_32x32x16_bf16 v[64:79], v[180:183], v[244:247], v[64:79]
v_mfma_f32_32x32x16_bf16 v[16:31], v[184:187], v[248:251], v[16:31]
v_mfma_f32_32x32x16_bf16 v[32:47], v[188:191], v[248:251], v[32:47]
v_mfma_f32_32x32x16_bf16 v[48:63], v[184:187], v[252:255], v[48:63]
v_mfma_f32_32x32x16_bf16 v[64:79], v[188:191], v[252:255], v[64:79]
s_bitset1_b32 s86, 1
L_P3_4:
s_cmp_eq_u32 s86, 3
s_cbranch_scc1 L_P3_DONE
s_sub_u32 s46, s46, 1

s_cbranch_scc0 L_P3
s_branch L_P3_DONE
L_P3_2A:
s_waitcnt vmcnt(0)
s_branch L_P3_2A2
L_P3_DONE:
s_nop 9
ds_write_b128 v120, v[32:35] offset:0
ds_write_b128 v120, v[36:39] offset:1024
ds_write_b128 v120, v[40:43] offset:2048
ds_write_b128 v120, v[44:47] offset:3072
ds_write_b128 v121, v[48:51] offset:0
ds_write_b128 v121, v[52:55] offset:1024
ds_write_b128 v121, v[56:59] offset:2048
ds_write_b128 v121, v[60:63] offset:3072
ds_write_b128 v122, v[64:67] offset:0
ds_write_b128 v122, v[68:71] offset:1024
ds_write_b128 v122, v[72:75] offset:2048
ds_write_b128 v122, v[76:79] offset:3072
v_fmac_f32 v16, v80, v10
v_fmac_f32 v17, v81, v10
v_fmac_f32 v18, v82, v10
v_fmac_f32 v19, v83, v10
v_fmac_f32 v20, v84, v10
v_fmac_f32 v21, v85, v10
v_fmac_f32 v22, v86, v10
v_fmac_f32 v23, v87, v10
v_fmac_f32 v24, v88, v10
v_fmac_f32 v25, v89, v10
v_fmac_f32 v26, v90, v10
v_fmac_f32 v27, v91, v10
v_fmac_f32 v28, v92, v10
v_fmac_f32 v29, v93, v10
v_fmac_f32 v30, v94, v10
v_fmac_f32 v31, v95, v10
s_waitcnt lgkmcnt(0)
s_barrier
ds_read_b128 v[128:131], v123 offset:0
ds_read_b128 v[132:135], v123 offset:1024
ds_read_b128 v[136:139], v123 offset:2048
ds_read_b128 v[140:143], v123 offset:3072
ds_read_b128 v[144:147], v123 offset:4096
ds_read_b128 v[148:151], v123 offset:5120
ds_read_b128 v[152:155], v123 offset:6144
ds_read_b128 v[156:159], v123 offset:7168
ds_read_b128 v[160:163], v123 offset:8192
ds_read_b128 v[164:167], v123 offset:9216
ds_read_b128 v[168:171], v123 offset:10240
ds_read_b128 v[172:175], v123 offset:11264
s_waitcnt lgkmcnt(8)
v_pk_add_f32 v[16:17], v[16:17], v[128:129]
v_pk_add_f32 v[18:19], v[18:19], v[130:131]
v_pk_add_f32 v[20:21], v[20:21], v[132:133]
v_pk_add_f32 v[22:23], v[22:23], v[134:135]
v_pk_add_f32 v[24:25], v[24:25], v[136:137]
v_pk_add_f32 v[26:27], v[26:27], v[138:139]
v_pk_add_f32 v[28:29], v[28:29], v[140:141]
v_pk_add_f32 v[30:31], v[30:31], v[142:143]
s_waitcnt lgkmcnt(4)
v_pk_add_f32 v[16:17], v[16:17], v[144:145]
v_pk_add_f32 v[18:19], v[18:19], v[146:147]
v_pk_add_f32 v[20:21], v[20:21], v[148:149]
v_pk_add_f32 v[22:23], v[22:23], v[150:151]
v_pk_add_f32 v[24:25], v[24:25], v[152:153]
v_pk_add_f32 v[26:27], v[26:27], v[154:155]
v_pk_add_f32 v[28:29], v[28:29], v[156:157]
v_pk_add_f32 v[30:31], v[30:31], v[158:159]
s_waitcnt lgkmcnt(0)
v_pk_add_f32 v[16:17], v[16:17], v[160:161]
v_pk_add_f32 v[18:19], v[18:19], v[162:163]
v_pk_add_f32 v[20:21], v[20:21], v[164:165]
v_pk_add_f32 v[22:23], v[22:23], v[166:167]
v_pk_add_f32 v[24:25], v[24:25], v[168:169]
v_pk_add_f32 v[26:27], v[26:27], v[170:171]
v_pk_add_f32 v[28:29], v[28:29], v[172:173]
v_pk_add_f32 v[30:31], v[30:31], v[174:175]
v_cvt_pk_bf16_f32 v32, v16, v17
v_cvt_pk_bf16_f32 v33, v18, v19
v_cvt_pk_bf16_f32 v34, v20, v21
v_cvt_pk_bf16_f32 v35, v22, v23
v_cvt_pk_bf16_f32 v36, v24, v25
v_cvt_pk_bf16_f32 v37, v26, v27
v_cvt_pk_bf16_f32 v38, v28, v29
v_cvt_pk_bf16_f32 v39, v30, v31
buffer_store_dwordx4 v[32:35], v124, s[32:35], s74 offen
buffer_store_dwordx4 v[36:39], v124, s[32:35], s74 offen offset:32
L_END:
s_endpgm
L_G_EPCHK:
s_waitcnt vmcnt(0)
v_readfirstlane_b32 s64, v125
s_nop 0
s_cmp_eq_u32 s64, 0
s_cbranch_scc1 L_G_EPSPIN
L_G_EPOK:
v_mov_b32 v1, 161024
ds_write_b32 v1, v125
s_setpc_b64 s[72:73]
L_CSP:
s_setprio 2
v_add_u32 v3, s47, v103
ds_read_b64_tr_b16 v[32:33], v3 offset:0
ds_read_b64_tr_b16 v[34:35], v3 offset:2048
ds_read_b64_tr_b16 v[36:37], v3 offset:4096
ds_read_b64_tr_b16 v[38:39], v3 offset:6144
ds_read_b64_tr_b16 v[40:41], v3 offset:8192
ds_read_b64_tr_b16 v[42:43], v3 offset:10240
ds_read_b64_tr_b16 v[44:45], v3 offset:12288
ds_read_b64_tr_b16 v[46:47], v3 offset:14336
ds_read_b64_tr_b16 v[48:49], v3 offset:16384
ds_read_b64_tr_b16 v[50:51], v3 offset:18432
ds_read_b64_tr_b16 v[52:53], v3 offset:20480
ds_read_b64_tr_b16 v[54:55], v3 offset:22528
v_mov_b32 v76, 0x3f803f80
v_mov_b32 v77, v76
v_mov_b32 v78, v76
v_mov_b32 v79, v76
s_lshl_b32 s65, s4, 6
s_add_u32 s65, s65, s74
s_add_u32 s65, s65, 157696
s_waitcnt lgkmcnt(10)
v_mfma_f32_16x16x32_bf16 v[80:83], v[76:79], v[32:35], 0
ds_read_b64_tr_b16 v[56:57], v3 offset:24576
ds_read_b64_tr_b16 v[58:59], v3 offset:26624
s_waitcnt lgkmcnt(10)
v_mfma_f32_16x16x32_bf16 v[80:83], v[76:79], v[36:39], v[80:83]
ds_read_b64_tr_b16 v[60:61], v3 offset:28672
ds_read_b64_tr_b16 v[62:63], v3 offset:30720
s_waitcnt lgkmcnt(10)
v_mfma_f32_16x16x32_bf16 v[80:83], v[76:79], v[40:43], v[80:83]
ds_read_b64_tr_b16 v[32:33], v3 offset:32768
ds_read_b64_tr_b16 v[34:35], v3 offset:34816
s_waitcnt lgkmcnt(10)
v_mfma_f32_16x16x32_bf16 v[80:83], v[76:79], v[44:47], v[80:83]
ds_read_b64_tr_b16 v[36:37], v3 offset:36864
ds_read_b64_tr_b16 v[38:39], v3 offset:38912
s_waitcnt lgkmcnt(10)
v_mfma_f32_16x16x32_bf16 v[80:83], v[76:79], v[48:51], v[80:83]
ds_read_b64_tr_b16 v[40:41], v3 offset:40960
ds_read_b64_tr_b16 v[42:43], v3 offset:43008
s_waitcnt lgkmcnt(10)
v_mfma_f32_16x16x32_bf16 v[80:83], v[76:79], v[52:55], v[80:83]
ds_read_b64_tr_b16 v[44:45], v3 offset:45056
ds_read_b64_tr_b16 v[46:47], v3 offset:47104
s_waitcnt lgkmcnt(10)
v_mfma_f32_16x16x32_bf16 v[80:83], v[76:79], v[56:59], v[80:83]
ds_read_b64_tr_b16 v[48:49], v3 offset:49152
ds_read_b64_tr_b16 v[50:51], v3 offset:51200
s_waitcnt lgkmcnt(10)
v_mfma_f32_16x16x32_bf16 v[80:83], v[76:79], v[60:63], v[80:83]
ds_read_b64_tr_b16 v[52:53], v3 offset:53248
ds_read_b64_tr_b16 v[54:55], v3 offset:55296
s_waitcnt lgkmcnt(10)
v_mfma_f32_16x16x32_bf16 v[80:83], v[76:79], v[32:35], v[80:83]
ds_read_b64_tr_b16 v[56:57], v3 offset:57344
ds_read_b64_tr_b16 v[58:59], v3 offset:59392
s_waitcnt lgkmcnt(10)
v_mfma_f32_16x16x32_bf16 v[80:83], v[76:79], v[36:39], v[80:83]
ds_read_b64_tr_b16 v[60:61], v3 offset:61440
ds_read_b64_tr_b16 v[62:63], v3 offset:63488
s_waitcnt lgkmcnt(10)
v_mfma_f32_16x16x32_bf16 v[80:83], v[76:79], v[40:43], v[80:83]
s_waitcnt lgkmcnt(8)
v_mfma_f32_16x16x32_bf16 v[80:83], v[76:79], v[44:47], v[80:83]
s_waitcnt lgkmcnt(6)
v_mfma_f32_16x16x32_bf16 v[80:83], v[76:79], v[48:51], v[80:83]
s_waitcnt lgkmcnt(4)
v_mfma_f32_16x16x32_bf16 v[80:83], v[76:79], v[52:55], v[80:83]
s_waitcnt lgkmcnt(2)
v_mfma_f32_16x16x32_bf16 v[80:83], v[76:79], v[56:59], v[80:83]
s_waitcnt lgkmcnt(0)
v_mfma_f32_16x16x32_bf16 v[80:83], v[76:79], v[60:63], v[80:83]
v_and_b32 v3, 15, v0
v_lshlrev_b32 v3, 2, v3
v_add_u32 v3, s65, v3
s_nop 4
ds_write_b32 v3, v80
s_setprio 0
s_setpc_b64 s[72:73]
L_TILE:
ds_read_b64_tr_b16 v[64:65], v11 offset:0
ds_read_b64_tr_b16 v[66:67], v11 offset:512
ds_read_b64_tr_b16 v[68:69], v11 offset:2048
ds_read_b64_tr_b16 v[70:71], v11 offset:2560
s_waitcnt lgkmcnt(2)
v_mfma_f32_32x32x16_bf16 v[16:31], v[64:67], v[128:131], 0
ds_read_b64_tr_b16 v[72:73], v11 offset:4096
ds_read_b64_tr_b16 v[74:75], v11 offset:4608
s_waitcnt lgkmcnt(2)
v_mfma_f32_32x32x16_bf16 v[16:31], v[68:71], v[132:135], v[16:31]
ds_read_b64_tr_b16 v[64:65], v11 offset:6144
ds_read_b64_tr_b16 v[66:67], v11 offset:6656
s_waitcnt lgkmcnt(2)
v_mfma_f32_32x32x16_bf16 v[16:31], v[72:75], v[136:139], v[16:31]
ds_read_b64_tr_b16 v[68:69], v11 offset:8192
ds_read_b64_tr_b16 v[70:71], v11 offset:8704
s_waitcnt lgkmcnt(2)
v_mfma_f32_32x32x16_bf16 v[16:31], v[64:67], v[140:143], v[16:31]
ds_read_b64_tr_b16 v[72:73], v11 offset:10240
ds_read_b64_tr_b16 v[74:75], v11 offset:10752
s_waitcnt lgkmcnt(2)
v_mfma_f32_32x32x16_bf16 v[16:31], v[68:71], v[144:147], v[16:31]
ds_read_b64_tr_b16 v[64:65], v11 offset:12288
ds_read_b64_tr_b16 v[66:67], v11 offset:12800
s_waitcnt lgkmcnt(2)
v_mfma_f32_32x32x16_bf16 v[16:31], v[72:75], v[148:151], v[16:31]
ds_read_b64_tr_b16 v[68:69], v11 offset:14336
ds_read_b64_tr_b16 v[70:71], v11 offset:14848
s_waitcnt lgkmcnt(2)
v_mfma_f32_32x32x16_bf16 v[16:31], v[64:67], v[152:155], v[16:31]
ds_read_b64_tr_b16 v[72:73], v11 offset:16384
ds_read_b64_tr_b16 v[74:75], v11 offset:16896
s_waitcnt lgkmcnt(2)
v_mfma_f32_32x32x16_bf16 v[16:31], v[68:71], v[156:159], v[16:31]
ds_read_b64_tr_b16 v[64:65], v11 offset:18432
ds_read_b64_tr_b16 v[66:67], v11 offset:18944
s_waitcnt lgkmcnt(2)
v_mfma_f32_32x32x16_bf16 v[16:31], v[72:75], v[160:163], v[16:31]
ds_read_b64_tr_b16 v[68:69], v11 offset:20480
ds_read_b64_tr_b16 v[70:71], v11 offset:20992
s_waitcnt lgkmcnt(2)
v_mfma_f32_32x32x16_bf16 v[16:31], v[64:67], v[164:167], v[16:31]
ds_read_b64_tr_b16 v[72:73], v11 offset:22528
ds_read_b64_tr_b16 v[74:75], v11 offset:23040
s_waitcnt lgkmcnt(2)
v_mfma_f32_32x32x16_bf16 v[16:31], v[68:71], v[168:171], v[16:31]
ds_read_b64_tr_b16 v[64:65], v11 offset:24576
ds_read_b64_tr_b16 v[66:67], v11 offset:25088
s_waitcnt lgkmcnt(2)
v_mfma_f32_32x32x16_bf16 v[16:31], v[72:75], v[172:175], v[16:31]
ds_read_b64_tr_b16 v[68:69], v11 offset:26624
ds_read_b64_tr_b16 v[70:71], v11 offset:27136
s_waitcnt lgkmcnt(2)
v_mfma_f32_32x32x16_bf16 v[16:31], v[64:67], v[176:179], v[16:31]
ds_read_b64_tr_b16 v[72:73], v11 offset:28672
ds_read_b64_tr_b16 v[74:75], v11 offset:29184
s_waitcnt lgkmcnt(2)
v_mfma_f32_32x32x16_bf16 v[16:31], v[68:71], v[180:183], v[16:31]
ds_read_b64_tr_b16 v[64:65], v11 offset:30720
ds_read_b64_tr_b16 v[66:67], v11 offset:31232
s_waitcnt lgkmcnt(2)
v_mfma_f32_32x32x16_bf16 v[16:31], v[72:75], v[184:187], v[16:31]
ds_read_b64_tr_b16 v[68:69], v11 offset:32768
ds_read_b64_tr_b16 v[70:71], v11 offset:33280
s_waitcnt lgkmcnt(2)
v_mfma_f32_32x32x16_bf16 v[16:31], v[64:67], v[188:191], v[16:31]
ds_read_b64_tr_b16 v[72:73], v11 offset:34816
ds_read_b64_tr_b16 v[74:75], v11 offset:35328
s_waitcnt lgkmcnt(2)
v_mfma_f32_32x32x16_bf16 v[16:31], v[68:71], v[192:195], v[16:31]
ds_read_b64_tr_b16 v[64:65], v11 offset:36864
ds_read_b64_tr_b16 v[66:67], v11 offset:37376
s_waitcnt lgkmcnt(2)
v_mfma_f32_32x32x16_bf16 v[16:31], v[72:75], v[196:199], v[16:31]
ds_read_b64_tr_b16 v[68:69], v11 offset:38912
ds_read_b64_tr_b16 v[70:71], v11 offset:39424
s_waitcnt lgkmcnt(2)
v_mfma_f32_32x32x16_bf16 v[16:31], v[64:67], v[200:203], v[16:31]
ds_read_b64_tr_b16 v[72:73], v11 offset:40960
ds_read_b64_tr_b16 v[74:75], v11 offset:41472
s_waitcnt lgkmcnt(2)
v_mfma_f32_32x32x16_bf16 v[16:31], v[68:71], v[204:207], v[16:31]
ds_read_b64_tr_b16 v[64:65], v11 offset:43008
ds_read_b64_tr_b16 v[66:67], v11 offset:43520
s_waitcnt lgkmcnt(2)
v_mfma_f32_32x32x16_bf16 v[16:31], v[72:75], v[208:211], v[16:31]
ds_read_b64_tr_b16 v[68:69], v11 offset:45056
ds_read_b64_tr_b16 v[70:71], v11 offset:45568
s_waitcnt lgkmcnt(2)
v_mfma_f32_32x32x16_bf16 v[16:31], v[64:67], v[212:215], v[16:31]
ds_read_b64_tr_b16 v[72:73], v11 offset:47104
ds_read_b64_tr_b16 v[74:75], v11 offset:47616
s_waitcnt lgkmcnt(2)
v_mfma_f32_32x32x16_bf16 v[16:31], v[68:71], v[216:219], v[16:31]
ds_read_b64_tr_b16 v[64:65], v11 offset:49152
ds_read_b64_tr_b16 v[66:67], v11 offset:49664
s_waitcnt lgkmcnt(2)
v_mfma_f32_32x32x16_bf16 v[16:31], v[72:75], v[220:223], v[16:31]
ds_read_b64_tr_b16 v[68:69], v11 offset:51200
ds_read_b64_tr_b16 v[70:71], v11 offset:51712
s_waitcnt lgkmcnt(2)
v_mfma_f32_32x32x16_bf16 v[16:31], v[64:67], v[224:227], v[16:31]
ds_read_b64_tr_b16 v[72:73], v11 offset:53248
ds_read_b64_tr_b16 v[74:75], v11 offset:53760
s_waitcnt lgkmcnt(2)
v_mfma_f32_32x32x16_bf16 v[16:31], v[68:71], v[228:231], v[16:31]
ds_read_b64_tr_b16 v[64:65], v11 offset:55296
ds_read_b64_tr_b16 v[66:67], v11 offset:55808
s_waitcnt lgkmcnt(2)
v_mfma_f32_32x32x16_bf16 v[16:31], v[72:75], v[232:235], v[16:31]
ds_read_b64_tr_b16 v[68:69], v11 offset:57344
ds_read_b64_tr_b16 v[70:71], v11 offset:57856
s_waitcnt lgkmcnt(2)
v_mfma_f32_32x32x16_bf16 v[16:31], v[64:67], v[236:239], v[16:31]
ds_read_b64_tr_b16 v[72:73], v11 offset:59392
ds_read_b64_tr_b16 v[74:75], v11 offset:59904
s_waitcnt lgkmcnt(2)
v_mfma_f32_32x32x16_bf16 v[16:31], v[68:71], v[240:243], v[16:31]
ds_read_b64_tr_b16 v[64:65], v11 offset:61440
ds_read_b64_tr_b16 v[66:67], v11 offset:61952
s_waitcnt lgkmcnt(2)
v_mfma_f32_32x32x16_bf16 v[16:31], v[72:75], v[244:247], v[16:31]
ds_read_b64_tr_b16 v[68:69], v11 offset:63488
ds_read_b64_tr_b16 v[70:71], v11 offset:64000
s_waitcnt lgkmcnt(2)
v_mfma_f32_32x32x16_bf16 v[16:31], v[64:67], v[248:251], v[16:31]
s_waitcnt lgkmcnt(0)
v_mfma_f32_32x32x16_bf16 v[16:31], v[68:71], v[252:255], v[16:31]
s_setpc_b64 s[72:73]
L_G_EPSPIN:
s_mov_b32 s46, 100000
v_mov_b32 v1, 0
L_G_EPSPIN2:
buffer_load_dword v125, v1, s[36:39], 0 offen sc1
s_waitcnt vmcnt(0)
v_readfirstlane_b32 s64, v125
s_sub_u32 s46, s46, 1
s_cbranch_scc1 L_G_EPOK
s_cmp_eq_u32 s64, 0
s_cbranch_scc1 L_G_EPSPIN2
s_branch L_G_EPOK
L_DMAKV:
s_lshl_b32 s65, s4, 11
s_add_u32 s47, s47, s65
s_lshl_b32 s66, s82, 16
s_add_u32 s66, s66, s65
s_lshl_b32 s65, s83, 3
s_add_u32 s65, s65, s74
s_and_b32 s65, s65, 63
s_lshl_b32 s67, s65, 10
s_add_u32 s67, s67, s66
s_add_u32 s65, s65, 8
s_add_u32 m0, s47, 0
s_add_u32 s68, s67, 2097152
buffer_load_dwordx4 v14, s[28:31], s68 offen offset:0 sc1 lds
buffer_load_dwordx4 v14, s[28:31], s68 offen offset:1024 sc1 lds
s_add_u32 m0, s47, 32768
s_add_u32 s68, s67, 4194304
buffer_load_dwordx4 v14, s[28:31], s68 offen offset:0 sc1 lds
buffer_load_dwordx4 v14, s[28:31], s68 offen offset:1024 sc1 lds
s_and_b32 s65, s65, 63
s_lshl_b32 s67, s65, 10
s_add_u32 s67, s67, s66
s_add_u32 s65, s65, 8
s_add_u32 m0, s47, 8192
s_add_u32 s68, s67, 2097152
buffer_load_dwordx4 v14, s[28:31], s68 offen offset:0 sc1 lds
buffer_load_dwordx4 v14, s[28:31], s68 offen offset:1024 sc1 lds
s_add_u32 m0, s47, 40960
s_add_u32 s68, s67, 4194304
buffer_load_dwordx4 v14, s[28:31], s68 offen offset:0 sc1 lds
buffer_load_dwordx4 v14, s[28:31], s68 offen offset:1024 sc1 lds
s_setpc_b64 s[72:73]
L_TILEW:
ds_read_b64_tr_b16 v[64:65], v11 offset:0
ds_read_b64_tr_b16 v[66:67], v11 offset:512
ds_read_b64_tr_b16 v[68:69], v11 offset:2048
ds_read_b64_tr_b16 v[70:71], v11 offset:2560
s_waitcnt lgkmcnt(2)
v_mfma_f32_32x32x16_bf16 v[16:31], v[64:67], v[128:131], 0
s_lshl_b32 s65, s99, 13
s_add_u32 m0, s65, s97
s_mul_i32 s66, s100, 229376
s_add_u32 s66, s66, s98
ds_read_b64_tr_b16 v[72:73], v11 offset:4096
ds_read_b64_tr_b16 v[74:75], v11 offset:4608
buffer_load_dwordx4 v117, s[16:19], s66 offen lds
s_waitcnt lgkmcnt(2)
v_mfma_f32_32x32x16_bf16 v[16:31], v[68:71], v[132:135], v[16:31]
ds_read_b64_tr_b16 v[64:65], v11 offset:6144
ds_read_b64_tr_b16 v[66:67], v11 offset:6656
buffer_load_dwordx4 v119, s[16:19], s66 offen offset:1024 lds
s_waitcnt lgkmcnt(2)
v_mfma_f32_32x32x16_bf16 v[16:31], v[72:75], v[136:139], v[16:31]
ds_read_b64_tr_b16 v[68:69], v11 offset:8192
ds_read_b64_tr_b16 v[70:71], v11 offset:8704
s_add_u32 s99, s99, 1
s_and_b32 s99, s99, 7
s_add_u32 s100, s100, 1
s_and_b32 s100, s100, 7
s_waitcnt lgkmcnt(2)
v_mfma_f32_32x32x16_bf16 v[16:31], v[64:67], v[140:143], v[16:31]
s_lshl_b32 s65, s99, 13
s_add_u32 m0, s65, s97
s_mul_i32 s66, s100, 229376
s_add_u32 s66, s66, s98
ds_read_b64_tr_b16 v[72:73], v11 offset:10240
ds_read_b64_tr_b16 v[74:75], v11 offset:10752
buffer_load_dwordx4 v117, s[16:19], s66 offen lds
s_waitcnt lgkmcnt(2)
v_mfma_f32_32x32x16_bf16 v[16:31], v[68:71], v[144:147], v[16:31]
ds_read_b64_tr_b16 v[64:65], v11 offset:12288
ds_read_b64_tr_b16 v[66:67], v11 offset:12800
buffer_load_dwordx4 v119, s[16:19], s66 offen offset:1024 lds
s_waitcnt lgkmcnt(2)
v_mfma_f32_32x32x16_bf16 v[16:31], v[72:75], v[148:151], v[16:31]
ds_read_b64_tr_b16 v[68:69], v11 offset:14336
ds_read_b64_tr_b16 v[70:71], v11 offset:14848
s_add_u32 s99, s99, 1
s_and_b32 s99, s99, 7
s_add_u32 s100, s100, 1
s_and_b32 s100, s100, 7
s_waitcnt lgkmcnt(2)
v_mfma_f32_32x32x16_bf16 v[16:31], v[64:67], v[152:155], v[16:31]
s_lshl_b32 s65, s99, 13
s_add_u32 m0, s65, s97
s_mul_i32 s66, s100, 229376
s_add_u32 s66, s66, s98
ds_read_b64_tr_b16 v[72:73], v11 offset:16384
ds_read_b64_tr_b16 v[74:75], v11 offset:16896
buffer_load_dwordx4 v117, s[16:19], s66 offen lds
s_waitcnt lgkmcnt(2)
v_mfma_f32_32x32x16_bf16 v[16:31], v[68:71], v[156:159], v[16:31]
ds_read_b64_tr_b16 v[64:65], v11 offset:18432
ds_read_b64_tr_b16 v[66:67], v11 offset:18944
buffer_load_dwordx4 v119, s[16:19], s66 offen offset:1024 lds
s_waitcnt lgkmcnt(2)
v_mfma_f32_32x32x16_bf16 v[16:31], v[72:75], v[160:163], v[16:31]
ds_read_b64_tr_b16 v[68:69], v11 offset:20480
ds_read_b64_tr_b16 v[70:71], v11 offset:20992
s_add_u32 s99, s99, 1
s_and_b32 s99, s99, 7
s_add_u32 s100, s100, 1
s_and_b32 s100, s100, 7
s_waitcnt lgkmcnt(2)
v_mfma_f32_32x32x16_bf16 v[16:31], v[64:67], v[164:167], v[16:31]
s_lshl_b32 s65, s99, 13
s_add_u32 m0, s65, s97
s_mul_i32 s66, s100, 229376
s_add_u32 s66, s66, s98
ds_read_b64_tr_b16 v[72:73], v11 offset:22528
ds_read_b64_tr_b16 v[74:75], v11 offset:23040
buffer_load_dwordx4 v117, s[16:19], s66 offen lds
s_waitcnt lgkmcnt(2)
v_mfma_f32_32x32x16_bf16 v[16:31], v[68:71], v[168:171], v[16:31]
ds_read_b64_tr_b16 v[64:65], v11 offset:24576
ds_read_b64_tr_b16 v[66:67], v11 offset:25088
buffer_load_dwordx4 v119, s[16:19], s66 offen offset:1024 lds
s_waitcnt lgkmcnt(2)
v_mfma_f32_32x32x16_bf16 v[16:31], v[72:75], v[172:175], v[16:31]
ds_read_b64_tr_b16 v[68:69], v11 offset:26624
ds_read_b64_tr_b16 v[70:71], v11 offset:27136
s_add_u32 s99, s99, 1
s_and_b32 s99, s99, 7
s_add_u32 s100, s100, 1
s_and_b32 s100, s100, 7
s_waitcnt lgkmcnt(2)
v_mfma_f32_32x32x16_bf16 v[16:31], v[64:67], v[176:179], v[16:31]
s_lshl_b32 s65, s99, 13
s_add_u32 m0, s65, s97
s_mul_i32 s66, s100, 229376
s_add_u32 s66, s66, s98
ds_read_b64_tr_b16 v[72:73], v11 offset:28672
ds_read_b64_tr_b16 v[74:75], v11 offset:29184
buffer_load_dwordx4 v117, s[16:19], s66 offen lds
s_waitcnt lgkmcnt(2)
v_mfma_f32_32x32x16_bf16 v[16:31], v[68:71], v[180:183], v[16:31]
ds_read_b64_tr_b16 v[64:65], v11 offset:30720
ds_read_b64_tr_b16 v[66:67], v11 offset:31232
buffer_load_dwordx4 v119, s[16:19], s66 offen offset:1024 lds
s_waitcnt lgkmcnt(2)
v_mfma_f32_32x32x16_bf16 v[16:31], v[72:75], v[184:187], v[16:31]
ds_read_b64_tr_b16 v[68:69], v11 offset:32768
ds_read_b64_tr_b16 v[70:71], v11 offset:33280
s_add_u32 s99, s99, 1
s_and_b32 s99, s99, 7
s_add_u32 s100, s100, 1
s_and_b32 s100, s100, 7
s_waitcnt lgkmcnt(2)
v_mfma_f32_32x32x16_bf16 v[16:31], v[64:67], v[188:191], v[16:31]
s_lshl_b32 s65, s99, 13
s_add_u32 m0, s65, s97
s_mul_i32 s66, s100, 229376
s_add_u32 s66, s66, s98
ds_read_b64_tr_b16 v[72:73], v11 offset:34816
ds_read_b64_tr_b16 v[74:75], v11 offset:35328
buffer_load_dwordx4 v117, s[16:19], s66 offen lds
s_waitcnt lgkmcnt(2)
v_mfma_f32_32x32x16_bf16 v[16:31], v[68:71], v[192:195], v[16:31]
ds_read_b64_tr_b16 v[64:65], v11 offset:36864
ds_read_b64_tr_b16 v[66:67], v11 offset:37376
buffer_load_dwordx4 v119, s[16:19], s66 offen offset:1024 lds
s_waitcnt lgkmcnt(2)
v_mfma_f32_32x32x16_bf16 v[16:31], v[72:75], v[196:199], v[16:31]
ds_read_b64_tr_b16 v[68:69], v11 offset:38912
ds_read_b64_tr_b16 v[70:71], v11 offset:39424
s_add_u32 s99, s99, 1
s_and_b32 s99, s99, 7
s_add_u32 s100, s100, 1
s_and_b32 s100, s100, 7
s_waitcnt lgkmcnt(2)
v_mfma_f32_32x32x16_bf16 v[16:31], v[64:67], v[200:203], v[16:31]
s_lshl_b32 s65, s99, 13
s_add_u32 m0, s65, s97
s_mul_i32 s66, s100, 229376
s_add_u32 s66, s66, s98
ds_read_b64_tr_b16 v[72:73], v11 offset:40960
ds_read_b64_tr_b16 v[74:75], v11 offset:41472
buffer_load_dwordx4 v117, s[16:19], s66 offen lds
s_waitcnt lgkmcnt(2)
v_mfma_f32_32x32x16_bf16 v[16:31], v[68:71], v[204:207], v[16:31]
ds_read_b64_tr_b16 v[64:65], v11 offset:43008
ds_read_b64_tr_b16 v[66:67], v11 offset:43520
buffer_load_dwordx4 v119, s[16:19], s66 offen offset:1024 lds
s_waitcnt lgkmcnt(2)
v_mfma_f32_32x32x16_bf16 v[16:31], v[72:75], v[208:211], v[16:31]
ds_read_b64_tr_b16 v[68:69], v11 offset:45056
ds_read_b64_tr_b16 v[70:71], v11 offset:45568
s_add_u32 s99, s99, 1
s_and_b32 s99, s99, 7
s_add_u32 s100, s100, 1
s_and_b32 s100, s100, 7
s_waitcnt lgkmcnt(2)
v_mfma_f32_32x32x16_bf16 v[16:31], v[64:67], v[212:215], v[16:31]
ds_read_b64_tr_b16 v[72:73], v11 offset:47104
ds_read_b64_tr_b16 v[74:75], v11 offset:47616
s_waitcnt lgkmcnt(2)
v_mfma_f32_32x32x16_bf16 v[16:31], v[68:71], v[216:219], v[16:31]
ds_read_b64_tr_b16 v[64:65], v11 offset:49152
ds_read_b64_tr_b16 v[66:67], v11 offset:49664
s_waitcnt lgkmcnt(2)
v_mfma_f32_32x32x16_bf16 v[16:31], v[72:75], v[220:223], v[16:31]
ds_read_b64_tr_b16 v[68:69], v11 offset:51200
ds_read_b64_tr_b16 v[70:71], v11 offset:51712
s_waitcnt lgkmcnt(2)
v_mfma_f32_32x32x16_bf16 v[16:31], v[64:67], v[224:227], v[16:31]
ds_read_b64_tr_b16 v[72:73], v11 offset:53248
ds_read_b64_tr_b16 v[74:75], v11 offset:53760
s_waitcnt lgkmcnt(2)
v_mfma_f32_32x32x16_bf16 v[16:31], v[68:71], v[228:231], v[16:31]
ds_read_b64_tr_b16 v[64:65], v11 offset:55296
ds_read_b64_tr_b16 v[66:67], v11 offset:55808
s_waitcnt lgkmcnt(2)
v_mfma_f32_32x32x16_bf16 v[16:31], v[72:75], v[232:235], v[16:31]
ds_read_b64_tr_b16 v[68:69], v11 offset:57344
ds_read_b64_tr_b16 v[70:71], v11 offset:57856
s_waitcnt lgkmcnt(2)
v_mfma_f32_32x32x16_bf16 v[16:31], v[64:67], v[236:239], v[16:31]
ds_read_b64_tr_b16 v[72:73], v11 offset:59392
ds_read_b64_tr_b16 v[74:75], v11 offset:59904
s_waitcnt lgkmcnt(2)
v_mfma_f32_32x32x16_bf16 v[16:31], v[68:71], v[240:243], v[16:31]
ds_read_b64_tr_b16 v[64:65], v11 offset:61440
ds_read_b64_tr_b16 v[66:67], v11 offset:61952
s_waitcnt lgkmcnt(2)
v_mfma_f32_32x32x16_bf16 v[16:31], v[72:75], v[244:247], v[16:31]
ds_read_b64_tr_b16 v[68:69], v11 offset:63488
ds_read_b64_tr_b16 v[70:71], v11 offset:64000
s_waitcnt lgkmcnt(2)
v_mfma_f32_32x32x16_bf16 v[16:31], v[64:67], v[248:251], v[16:31]
s_waitcnt lgkmcnt(0)
v_mfma_f32_32x32x16_bf16 v[16:31], v[68:71], v[252:255], v[16:31]
s_setpc_b64 s[72:73]
L_TILEK:
ds_read_b64_tr_b16 v[64:65], v11 offset:0
ds_read_b64_tr_b16 v[66:67], v11 offset:512
ds_read_b64_tr_b16 v[68:69], v11 offset:2048
ds_read_b64_tr_b16 v[70:71], v11 offset:2560
s_waitcnt lgkmcnt(2)
v_mfma_f32_32x32x16_bf16 v[16:31], v[64:67], v[128:131], 0
s_add_u32 m0, s97, 0
s_and_b32 s99, s99, 63
s_lshl_b32 s66, s99, 10
s_add_u32 s66, s66, s98
s_add_u32 s99, s99, 8
s_add_u32 s65, s66, 2097152
ds_read_b64_tr_b16 v[72:73], v11 offset:4096
ds_read_b64_tr_b16 v[74:75], v11 offset:4608
buffer_load_dwordx4 v14, s[28:31], s65 offen offset:0 sc1 lds
s_waitcnt lgkmcnt(2)
v_mfma_f32_32x32x16_bf16 v[16:31], v[68:71], v[132:135], v[16:31]
ds_read_b64_tr_b16 v[64:65], v11 offset:6144
ds_read_b64_tr_b16 v[66:67], v11 offset:6656
s_waitcnt lgkmcnt(2)
v_mfma_f32_32x32x16_bf16 v[16:31], v[72:75], v[136:139], v[16:31]
ds_read_b64_tr_b16 v[68:69], v11 offset:8192
ds_read_b64_tr_b16 v[70:71], v11 offset:8704
buffer_load_dwordx4 v14, s[28:31], s65 offen offset:1024 sc1 lds
s_waitcnt lgkmcnt(2)
v_mfma_f32_32x32x16_bf16 v[16:31], v[64:67], v[140:143], v[16:31]
ds_read_b64_tr_b16 v[72:73], v11 offset:10240
ds_read_b64_tr_b16 v[74:75], v11 offset:10752
s_waitcnt lgkmcnt(2)
v_mfma_f32_32x32x16_bf16 v[16:31], v[68:71], v[144:147], v[16:31]
s_add_u32 m0, s97, 32768
s_add_u32 s65, s66, 4194304
ds_read_b64_tr_b16 v[64:65], v11 offset:12288
ds_read_b64_tr_b16 v[66:67], v11 offset:12800
buffer_load_dwordx4 v14, s[28:31], s65 offen offset:0 sc1 lds
s_waitcnt lgkmcnt(2)
v_mfma_f32_32x32x16_bf16 v[16:31], v[72:75], v[148:151], v[16:31]
ds_read_b64_tr_b16 v[68:69], v11 offset:14336
ds_read_b64_tr_b16 v[70:71], v11 offset:14848
s_waitcnt lgkmcnt(2)
v_mfma_f32_32x32x16_bf16 v[16:31], v[64:67], v[152:155], v[16:31]
ds_read_b64_tr_b16 v[72:73], v11 offset:16384
ds_read_b64_tr_b16 v[74:75], v11 offset:16896
buffer_load_dwordx4 v14, s[28:31], s65 offen offset:1024 sc1 lds
s_waitcnt lgkmcnt(2)
v_mfma_f32_32x32x16_bf16 v[16:31], v[68:71], v[156:159], v[16:31]
ds_read_b64_tr_b16 v[64:65], v11 offset:18432
ds_read_b64_tr_b16 v[66:67], v11 offset:18944
s_waitcnt lgkmcnt(2)
v_mfma_f32_32x32x16_bf16 v[16:31], v[72:75], v[160:163], v[16:31]
s_add_u32 m0, s97, 8192
s_and_b32 s99, s99, 63
s_lshl_b32 s66, s99, 10
s_add_u32 s66, s66, s98
s_add_u32 s99, s99, 8
s_add_u32 s65, s66, 2097152
ds_read_b64_tr_b16 v[68:69], v11 offset:20480
ds_read_b64_tr_b16 v[70:71], v11 offset:20992
buffer_load_dwordx4 v14, s[28:31], s65 offen offset:0 sc1 lds
s_waitcnt lgkmcnt(2)
v_mfma_f32_32x32x16_bf16 v[16:31], v[64:67], v[164:167], v[16:31]
ds_read_b64_tr_b16 v[72:73], v11 offset:22528
ds_read_b64_tr_b16 v[74:75], v11 offset:23040
s_waitcnt lgkmcnt(2)
v_mfma_f32_32x32x16_bf16 v[16:31], v[68:71], v[168:171], v[16:31]
ds_read_b64_tr_b16 v[64:65], v11 offset:24576
ds_read_b64_tr_b16 v[66:67], v11 offset:25088
buffer_load_dwordx4 v14, s[28:31], s65 offen offset:1024 sc1 lds
s_waitcnt lgkmcnt(2)
v_mfma_f32_32x32x16_bf16 v[16:31], v[72:75], v[172:175], v[16:31]
ds_read_b64_tr_b16 v[68:69], v11 offset:26624
ds_read_b64_tr_b16 v[70:71], v11 offset:27136
s_waitcnt lgkmcnt(2)
v_mfma_f32_32x32x16_bf16 v[16:31], v[64:67], v[176:179], v[16:31]
s_add_u32 m0, s97, 40960
s_add_u32 s65, s66, 4194304
ds_read_b64_tr_b16 v[72:73], v11 offset:28672
ds_read_b64_tr_b16 v[74:75], v11 offset:29184
buffer_load_dwordx4 v14, s[28:31], s65 offen offset:0 sc1 lds
s_waitcnt lgkmcnt(2)
v_mfma_f32_32x32x16_bf16 v[16:31], v[68:71], v[180:183], v[16:31]
ds_read_b64_tr_b16 v[64:65], v11 offset:30720
ds_read_b64_tr_b16 v[66:67], v11 offset:31232
s_waitcnt lgkmcnt(2)
v_mfma_f32_32x32x16_bf16 v[16:31], v[72:75], v[184:187], v[16:31]
ds_read_b64_tr_b16 v[68:69], v11 offset:32768
ds_read_b64_tr_b16 v[70:71], v11 offset:33280
buffer_load_dwordx4 v14, s[28:31], s65 offen offset:1024 sc1 lds
s_waitcnt lgkmcnt(2)
v_mfma_f32_32x32x16_bf16 v[16:31], v[64:67], v[188:191], v[16:31]
ds_read_b64_tr_b16 v[72:73], v11 offset:34816
ds_read_b64_tr_b16 v[74:75], v11 offset:35328
s_waitcnt lgkmcnt(2)
v_mfma_f32_32x32x16_bf16 v[16:31], v[68:71], v[192:195], v[16:31]
ds_read_b64_tr_b16 v[64:65], v11 offset:36864
ds_read_b64_tr_b16 v[66:67], v11 offset:37376
s_waitcnt lgkmcnt(2)
v_mfma_f32_32x32x16_bf16 v[16:31], v[72:75], v[196:199], v[16:31]
ds_read_b64_tr_b16 v[68:69], v11 offset:38912
ds_read_b64_tr_b16 v[70:71], v11 offset:39424
s_waitcnt lgkmcnt(2)
v_mfma_f32_32x32x16_bf16 v[16:31], v[64:67], v[200:203], v[16:31]
ds_read_b64_tr_b16 v[72:73], v11 offset:40960
ds_read_b64_tr_b16 v[74:75], v11 offset:41472
s_waitcnt lgkmcnt(2)
v_mfma_f32_32x32x16_bf16 v[16:31], v[68:71], v[204:207], v[16:31]
ds_read_b64_tr_b16 v[64:65], v11 offset:43008
ds_read_b64_tr_b16 v[66:67], v11 offset:43520
s_waitcnt lgkmcnt(2)
v_mfma_f32_32x32x16_bf16 v[16:31], v[72:75], v[208:211], v[16:31]
ds_read_b64_tr_b16 v[68:69], v11 offset:45056
ds_read_b64_tr_b16 v[70:71], v11 offset:45568
s_waitcnt lgkmcnt(2)
v_mfma_f32_32x32x16_bf16 v[16:31], v[64:67], v[212:215], v[16:31]
ds_read_b64_tr_b16 v[72:73], v11 offset:47104
ds_read_b64_tr_b16 v[74:75], v11 offset:47616
s_waitcnt lgkmcnt(2)
v_mfma_f32_32x32x16_bf16 v[16:31], v[68:71], v[216:219], v[16:31]
ds_read_b64_tr_b16 v[64:65], v11 offset:49152
ds_read_b64_tr_b16 v[66:67], v11 offset:49664
s_waitcnt lgkmcnt(2)
v_mfma_f32_32x32x16_bf16 v[16:31], v[72:75], v[220:223], v[16:31]
ds_read_b64_tr_b16 v[68:69], v11 offset:51200
ds_read_b64_tr_b16 v[70:71], v11 offset:51712
s_waitcnt lgkmcnt(2)
v_mfma_f32_32x32x16_bf16 v[16:31], v[64:67], v[224:227], v[16:31]
ds_read_b64_tr_b16 v[72:73], v11 offset:53248
ds_read_b64_tr_b16 v[74:75], v11 offset:53760
s_waitcnt lgkmcnt(2)
v_mfma_f32_32x32x16_bf16 v[16:31], v[68:71], v[228:231], v[16:31]
ds_read_b64_tr_b16 v[64:65], v11 offset:55296
ds_read_b64_tr_b16 v[66:67], v11 offset:55808
s_waitcnt lgkmcnt(2)
v_mfma_f32_32x32x16_bf16 v[16:31], v[72:75], v[232:235], v[16:31]
ds_read_b64_tr_b16 v[68:69], v11 offset:57344
ds_read_b64_tr_b16 v[70:71], v11 offset:57856
s_waitcnt lgkmcnt(2)
v_mfma_f32_32x32x16_bf16 v[16:31], v[64:67], v[236:239], v[16:31]
ds_read_b64_tr_b16 v[72:73], v11 offset:59392
ds_read_b64_tr_b16 v[74:75], v11 offset:59904
s_waitcnt lgkmcnt(2)
v_mfma_f32_32x32x16_bf16 v[16:31], v[68:71], v[240:243], v[16:31]
ds_read_b64_tr_b16 v[64:65], v11 offset:61440
ds_read_b64_tr_b16 v[66:67], v11 offset:61952
s_waitcnt lgkmcnt(2)
v_mfma_f32_32x32x16_bf16 v[16:31], v[72:75], v[244:247], v[16:31]
ds_read_b64_tr_b16 v[68:69], v11 offset:63488
ds_read_b64_tr_b16 v[70:71], v11 offset:64000
s_waitcnt lgkmcnt(2)
v_mfma_f32_32x32x16_bf16 v[16:31], v[64:67], v[248:251], v[16:31]
s_waitcnt lgkmcnt(0)
v_mfma_f32_32x32x16_bf16 v[16:31], v[68:71], v[252:255], v[16:31]
s_setpc_b64 s[72:73]
L_EPI:
v_add_u32 v3, s47, v100
ds_read_b128 v[32:35], v3 offset:0
ds_read_b128 v[48:51], v3 offset:512
ds_read_b128 v[36:39], v3 offset:16
ds_read_b128 v[52:55], v3 offset:528
ds_read_b128 v[40:43], v3 offset:64
ds_read_b128 v[56:59], v3 offset:576
ds_read_b128 v[44:47], v3 offset:80
ds_read_b128 v[60:63], v3 offset:592
s_mov_b32 s65, 0xbdd2d3e8
s_nop 0
s_waitcnt lgkmcnt(4)
v_fma_f32 v48, v32, v13, v48
v_fma_f32 v49, v33, v13, v49
v_fma_f32 v50, v34, v13, v50
v_fma_f32 v51, v35, v13, v51
v_fma_f32 v52, v36, v13, v52
v_fma_f32 v53, v37, v13, v53
v_fma_f32 v54, v38, v13, v54
v_fma_f32 v55, v39, v13, v55
v_fma_f32 v16, v16, v12, v48
v_fma_f32 v17, v17, v12, v49
v_fma_f32 v18, v18, v12, v50
v_fma_f32 v19, v19, v12, v51
v_fma_f32 v20, v20, v12, v52
v_fma_f32 v21, v21, v12, v53
v_fma_f32 v22, v22, v12, v54
v_fma_f32 v23, v23, v12, v55
v_mul_f32 v32, v16, v16
v_mul_f32 v33, v17, v17
v_mul_f32 v34, v18, v18
v_mul_f32 v35, v19, v19
v_mul_f32 v36, v20, v20
v_mul_f32 v37, v21, v21
v_mul_f32 v38, v22, v22
v_mul_f32 v39, v23, v23
v_fma_f32 v32, v32, s65, v101
v_fma_f32 v33, v33, s65, v101
v_fma_f32 v34, v34, s65, v101
v_fma_f32 v35, v35, s65, v101
v_fma_f32 v36, v36, s65, v101
v_fma_f32 v37, v37, s65, v101
v_fma_f32 v38, v38, s65, v101
v_fma_f32 v39, v39, s65, v101
v_mul_f32 v32, v32, v16
v_mul_f32 v33, v33, v17
v_mul_f32 v34, v34, v18
v_mul_f32 v35, v35, v19
v_mul_f32 v36, v36, v20
v_mul_f32 v37, v37, v21
v_mul_f32 v38, v38, v22
v_mul_f32 v39, v39, v23
v_exp_f32 v32, v32
v_exp_f32 v33, v33
v_exp_f32 v34, v34
v_exp_f32 v35, v35
v_exp_f32 v36, v36
v_exp_f32 v37, v37
v_exp_f32 v38, v38
v_exp_f32 v39, v39
v_fma_f32 v32, v32, v118, v118
v_fma_f32 v33, v33, v118, v118
v_fma_f32 v34, v34, v118, v118
v_fma_f32 v35, v35, v118, v118
v_fma_f32 v36, v36, v118, v118
v_fma_f32 v37, v37, v118, v118
v_fma_f32 v38, v38, v118, v118
v_fma_f32 v39, v39, v118, v118
v_rcp_f32 v32, v32
v_rcp_f32 v33, v33
v_rcp_f32 v34, v34
v_rcp_f32 v35, v35
v_rcp_f32 v36, v36
v_rcp_f32 v37, v37
v_rcp_f32 v38, v38
v_rcp_f32 v39, v39
v_mul_f32 v16, v16, v32
v_mul_f32 v17, v17, v33
v_mul_f32 v18, v18, v34
v_mul_f32 v19, v19, v35
v_mul_f32 v20, v20, v36
v_mul_f32 v21, v21, v37
v_mul_f32 v22, v22, v38
v_mul_f32 v23, v23, v39
v_cvt_pk_bf16_f32 v104, v16, v17
v_cvt_pk_bf16_f32 v105, v18, v19
v_cvt_pk_bf16_f32 v106, v20, v21
v_cvt_pk_bf16_f32 v107, v22, v23
s_waitcnt lgkmcnt(0)
v_fma_f32 v56, v40, v13, v56
v_fma_f32 v57, v41, v13, v57
v_fma_f32 v58, v42, v13, v58
v_fma_f32 v59, v43, v13, v59
v_fma_f32 v60, v44, v13, v60
v_fma_f32 v61, v45, v13, v61
v_fma_f32 v62, v46, v13, v62
v_fma_f32 v63, v47, v13, v63
v_fma_f32 v24, v24, v12, v56
v_fma_f32 v25, v25, v12, v57
v_fma_f32 v26, v26, v12, v58
v_fma_f32 v27, v27, v12, v59
v_fma_f32 v28, v28, v12, v60
v_fma_f32 v29, v29, v12, v61
v_fma_f32 v30, v30, v12, v62
v_fma_f32 v31, v31, v12, v63
v_mul_f32 v40, v24, v24
v_mul_f32 v41, v25, v25
v_mul_f32 v42, v26, v26
v_mul_f32 v43, v27, v27
v_mul_f32 v44, v28, v28
v_mul_f32 v45, v29, v29
v_mul_f32 v46, v30, v30
v_mul_f32 v47, v31, v31
v_fma_f32 v40, v40, s65, v101
v_fma_f32 v41, v41, s65, v101
v_fma_f32 v42, v42, s65, v101
v_fma_f32 v43, v43, s65, v101
v_fma_f32 v44, v44, s65, v101
v_fma_f32 v45, v45, s65, v101
v_fma_f32 v46, v46, s65, v101
v_fma_f32 v47, v47, s65, v101
v_mul_f32 v40, v40, v24
v_mul_f32 v41, v41, v25
v_mul_f32 v42, v42, v26
v_mul_f32 v43, v43, v27
v_mul_f32 v44, v44, v28
v_mul_f32 v45, v45, v29
v_mul_f32 v46, v46, v30
v_mul_f32 v47, v47, v31
v_exp_f32 v40, v40
v_exp_f32 v41, v41
v_exp_f32 v42, v42
v_exp_f32 v43, v43
v_exp_f32 v44, v44
v_exp_f32 v45, v45
v_exp_f32 v46, v46
v_exp_f32 v47, v47
v_fma_f32 v40, v40, v118, v118
v_fma_f32 v41, v41, v118, v118
v_fma_f32 v42, v42, v118, v118
v_fma_f32 v43, v43, v118, v118
v_fma_f32 v44, v44, v118, v118
v_fma_f32 v45, v45, v118, v118
v_fma_f32 v46, v46, v118, v118
v_fma_f32 v47, v47, v118, v118
v_rcp_f32 v40, v40
v_rcp_f32 v41, v41
v_rcp_f32 v42, v42
v_rcp_f32 v43, v43
v_rcp_f32 v44, v44
v_rcp_f32 v45, v45
v_rcp_f32 v46, v46
v_rcp_f32 v47, v47
v_mul_f32 v24, v24, v40
v_mul_f32 v25, v25, v41
v_mul_f32 v26, v26, v42
v_mul_f32 v27, v27, v43
v_mul_f32 v28, v28, v44
v_mul_f32 v29, v29, v45
v_mul_f32 v30, v30, v46
v_mul_f32 v31, v31, v47
v_cvt_pk_bf16_f32 v108, v24, v25
v_cvt_pk_bf16_f32 v109, v26, v27
v_cvt_pk_bf16_f32 v110, v28, v29
v_cvt_pk_bf16_f32 v111, v30, v31
s_setpc_b64 s[72:73]
.p2align 6
L_ATT_RUN:
v_exp_f32 v128, v128
v_exp_f32 v129, v129
v_smfmac_f32_32x32x32_bf16 v[176:191], v[244:247], v[152:159], v96
ds_read_b128 v[240:243], v98 offset:1024
v_exp_f32 v130, v130
v_exp_f32 v131, v131
v_exp_f32 v132, v132
v_mfma_f32_32x32x16_bf16 v[144:159], v[224:227], v[124:127], v[208:223]
s_waitcnt lgkmcnt(1)
v_exp_f32 v133, v133
v_exp_f32 v134, v134
v_exp_f32 v135, v135
v_exp_f32 v136, v136
v_exp_f32 v137, v137
v_smfmac_f32_32x32x32_bf16 v[160:175], v[232:235], v[128:135], v96
ds_read_b128 v[244:247], v98 offset:1536
ds_read_b128 v[224:227], v97 offset:2048
v_exp_f32 v138, v138
v_exp_f32 v139, v139
v_exp_f32 v140, v140
v_exp_f32 v141, v141
v_exp_f32 v142, v142
v_exp_f32 v143, v143
v_exp_f32 v144, v144
v_exp_f32 v145, v145
v_smfmac_f32_32x32x32_bf16 v[160:175], v[236:239], v[136:143], v96
v_exp_f32 v146, v146
v_exp_f32 v147, v147
v_exp_f32 v148, v148
v_mfma_f32_32x32x16_bf16 v[128:143], v[228:231], v[120:123], v[192:207]
v_exp_f32 v149, v149
v_exp_f32 v150, v150
v_exp_f32 v151, v151
v_exp_f32 v152, v152
v_exp_f32 v153, v153
v_smfmac_f32_32x32x32_bf16 v[176:191], v[232:235], v[144:151], v96
v_exp_f32 v154, v154
v_exp_f32 v155, v155
v_exp_f32 v156, v156
v_exp_f32 v157, v157
v_exp_f32 v158, v158
v_exp_f32 v159, v159
v_exp_f32 v128, v128
v_exp_f32 v129, v129
v_smfmac_f32_32x32x32_bf16 v[176:191], v[236:239], v[152:159], v96
ds_read_b128 v[232:235], v98 offset:2048
v_exp_f32 v130, v130
v_exp_f32 v131, v131
v_exp_f32 v132, v132
v_mfma_f32_32x32x16_bf16 v[144:159], v[228:231], v[124:127], v[208:223]
s_waitcnt lgkmcnt(1)
v_exp_f32 v133, v133
v_exp_f32 v134, v134
v_exp_f32 v135, v135
v_exp_f32 v136, v136
v_exp_f32 v137, v137
v_smfmac_f32_32x32x32_bf16 v[160:175], v[240:243], v[128:135], v96
ds_read_b128 v[236:239], v98 offset:2560
ds_read_b128 v[228:231], v97 offset:3072
v_exp_f32 v138, v138
v_exp_f32 v139, v139
v_exp_f32 v140, v140
v_exp_f32 v141, v141
v_exp_f32 v142, v142
v_exp_f32 v143, v143
v_exp_f32 v144, v144
v_exp_f32 v145, v145
v_smfmac_f32_32x32x32_bf16 v[160:175], v[244:247], v[136:143], v96
v_exp_f32 v146, v146
v_exp_f32 v147, v147
v_exp_f32 v148, v148
v_mfma_f32_32x32x16_bf16 v[128:143], v[224:227], v[120:123], v[192:207]
v_add_u32 v97, s88, v97
v_exp_f32 v149, v149
v_exp_f32 v150, v150
v_exp_f32 v151, v151
v_exp_f32 v152, v152
v_exp_f32 v153, v153
v_smfmac_f32_32x32x32_bf16 v[176:191], v[240:243], v[144:151], v96
v_exp_f32 v154, v154
v_exp_f32 v155, v155
v_exp_f32 v156, v156
v_exp_f32 v157, v157
v_exp_f32 v158, v158
v_exp_f32 v159, v159
v_exp_f32 v128, v128
v_exp_f32 v129, v129
v_smfmac_f32_32x32x32_bf16 v[176:191], v[244:247], v[152:159], v96
ds_read_b128 v[240:243], v98 offset:3072
v_exp_f32 v130, v130
v_exp_f32 v131, v131
v_exp_f32 v132, v132
v_mfma_f32_32x32x16_bf16 v[144:159], v[224:227], v[124:127], v[208:223]
s_waitcnt lgkmcnt(1)
v_exp_f32 v133, v133
v_exp_f32 v134, v134
v_exp_f32 v135, v135
v_exp_f32 v136, v136
v_exp_f32 v137, v137
v_smfmac_f32_32x32x32_bf16 v[160:175], v[232:235], v[128:135], v96
ds_read_b128 v[244:247], v98 offset:3584
ds_read_b128 v[224:227], v97 offset:0
v_exp_f32 v138, v138
v_exp_f32 v139, v139
v_exp_f32 v140, v140
v_exp_f32 v141, v141
v_exp_f32 v142, v142
v_exp_f32 v143, v143
v_exp_f32 v144, v144
v_exp_f32 v145, v145
v_smfmac_f32_32x32x32_bf16 v[160:175], v[236:239], v[136:143], v96
v_exp_f32 v146, v146
v_exp_f32 v147, v147
v_exp_f32 v148, v148
v_mfma_f32_32x32x16_bf16 v[128:143], v[228:231], v[120:123], v[192:207]
v_mad_i32_i24 v98, v99, s88, v98
v_exp_f32 v149, v149
v_exp_f32 v150, v150
v_exp_f32 v151, v151
v_exp_f32 v152, v152
v_exp_f32 v153, v153
v_smfmac_f32_32x32x32_bf16 v[176:191], v[232:235], v[144:151], v96
v_exp_f32 v154, v154
v_exp_f32 v155, v155
v_exp_f32 v156, v156
v_exp_f32 v157, v157
v_exp_f32 v158, v158
v_exp_f32 v159, v159
v_exp_f32 v128, v128
v_exp_f32 v129, v129
v_smfmac_f32_32x32x32_bf16 v[176:191], v[236:239], v[152:159], v96
ds_read_b128 v[232:235], v98 offset:0
v_exp_f32 v130, v130
v_exp_f32 v131, v131
v_exp_f32 v132, v132
v_mfma_f32_32x32x16_bf16 v[144:159], v[228:231], v[124:127], v[208:223]
s_waitcnt lgkmcnt(1)
v_exp_f32 v133, v133
v_exp_f32 v134, v134
v_exp_f32 v135, v135
v_exp_f32 v136, v136
v_exp_f32 v137, v137
v_smfmac_f32_32x32x32_bf16 v[160:175], v[240:243], v[128:135], v96
ds_read_b128 v[236:239], v98 offset:512
ds_read_b128 v[228:231], v97 offset:1024
v_exp_f32 v138, v138
v_exp_f32 v139, v139
v_exp_f32 v140, v140
v_exp_f32 v141, v141
v_exp_f32 v142, v142
v_exp_f32 v143, v143
v_exp_f32 v144, v144
v_exp_f32 v145, v145
v_smfmac_f32_32x32x32_bf16 v[160:175], v[244:247], v[136:143], v96
v_exp_f32 v146, v146
v_exp_f32 v147, v147
v_exp_f32 v148, v148
v_mfma_f32_32x32x16_bf16 v[128:143], v[224:227], v[120:123], v[192:207]
v_exp_f32 v149, v149
v_exp_f32 v150, v150
v_exp_f32 v151, v151
v_exp_f32 v152, v152
v_exp_f32 v153, v153
v_smfmac_f32_32x32x32_bf16 v[176:191], v[240:243], v[144:151], v96
s_sub_u32 s86, s86, 1
v_exp_f32 v154, v154
v_exp_f32 v155, v155
v_exp_f32 v156, v156
v_exp_f32 v157, v157
v_exp_f32 v158, v158
v_exp_f32 v159, v159
s_cbranch_scc0 L_ATT_RUN
s_setpc_b64 s[72:73]
s_endpgm
L_CODE_END:
.section .rodata,"a"
.p2align 6
.amdhsa_kernel gated_mix__mha_block__mixer_channel_mlp__prompt_kernel
  .amdhsa_next_free_vgpr 256
  .amdhsa_next_free_sgpr 102
  .amdhsa_accum_offset 256
  .amdhsa_group_segment_fixed_size 0
  .amdhsa_kernarg_size 96
  .amdhsa_user_sgpr_count 2
  .amdhsa_user_sgpr_kernarg_segment_ptr 1
  .amdhsa_system_sgpr_workgroup_id_x 1
  .amdhsa_float_denorm_mode_32 3
.end_amdhsa_kernel
```
